```python
import torch

def _softmax(x, axis=-1):
    return torch.softmax(x, dim=axis)
def _gelu(x):
    return torch.nn.functional.gelu(x, approximate="tanh")
def _silu(x):
    return torch.nn.functional.silu(x)
def _sigmoid(x):
    return torch.sigmoid(x)
def _layernorm(x, axis=-1, eps=1e-5):
    m = x.mean(dim=axis, keepdim=True)
    v = x.var(dim=axis, keepdim=True, unbiased=False)
    return (x - m) / torch.sqrt(v + eps)
def _scatter_add(tgt, idx, src, axis=0):
    return tgt.clone().index_add_(axis, idx, src)
def _segment_sum(src, seg, n):
    out = torch.zeros((n,) + src.shape[1:], dtype=src.dtype)
    return out.index_add_(0, seg, src)
def _pad(x, pw):
    flat = tuple(v for pair in reversed(pw) for v in pair)
    return torch.nn.functional.pad(x, flat)

kernel_name = 'parallel_sum__ssm_conv_h3__mixer_token_mlp__prompt'

def setup_inputs():

    _w = (lambda a: (lambda t: t.to(torch.bfloat16) if t.is_floating_point() else t)(torch.as_tensor(a)))
    def _A_setup():
        B, S, D = 1, 2048, 1024
        ks = 4
        return {
            "q": _w((lambda *s: torch.randn(*s, dtype=torch.bfloat16) * 0.05)(B, S, D)),
            "k": _w((lambda *s: torch.randn(*s, dtype=torch.bfloat16) * 0.2)(B, S, D)),
            "v": _w((lambda *s: torch.randn(*s, dtype=torch.bfloat16) * 0.2)(B, S, D)),
            "shift_k": _w((lambda *s: torch.randn(*s, dtype=torch.bfloat16) * 0.2)(D, ks) * 0.5),
            "ssm_k": _w((lambda *s: torch.randn(*s, dtype=torch.bfloat16) * 0.2)(D, S) * (1.0 / S ** 0.5)),
            "ssm_D": _w((lambda *s: torch.randn(*s, dtype=torch.bfloat16) * 0.2)(D)),
        }
    _A_in = _A_setup()

    def _B_setup():
        B, S, D, F = 1, 2048, 1024, 3584
        return {
            "x": _w((lambda *s: torch.randn(*s, dtype=torch.bfloat16) * 0.05)(B, S, D)),
            "w1": _w((lambda *s: torch.randn(*s, dtype=torch.bfloat16) * 0.4)(S, F) * (S ** -0.5)),
            "b1": _w((lambda *s: torch.randn(*s, dtype=torch.bfloat16) * 3.2)(F) * 0.02),
            "w2": _w((lambda *s: torch.randn(*s, dtype=torch.bfloat16) * 0.2)(F, S) * (F ** -0.5)),
            "b2": _w((lambda *s: torch.randn(*s, dtype=torch.bfloat16) * 0.4)(S) * 0.02),
        }
    _B_in = _B_setup()

    return {
        "A_q": _A_in["q"],
        "A_k": _A_in["k"],
        "A_v": _A_in["v"],
        "A_shift_k": _A_in["shift_k"],
        "A_ssm_k": _A_in["ssm_k"],
        "A_ssm_D": _A_in["ssm_D"],
        "B_x": _B_in["x"],
        "B_w1": _B_in["w1"],
        "B_b1": _B_in["b1"],
        "B_w2": _B_in["w2"],
        "B_b2": _B_in["b2"],
    }

def reference(A_q, A_k, A_v, A_shift_k, A_ssm_k, A_ssm_D, B_x, B_w1, B_b1, B_w2, B_b2):
    def _A_ref(q, k, v, shift_k, ssm_k, ssm_D):
        B, S, D = q.shape
        ks = shift_k.shape[-1]
        k_pad = _pad(k, ((0, 0), (ks - 1, 0), (0, 0)))
        k_shift = torch.zeros_like(k)
        for t in range(ks):
            k_shift = k_shift + k_pad[:, t:t + S, :] * shift_k[:, ks - 1 - t][None, None, :]
        kv = k_shift * v
        L = 2 * S
        kv_pad = _pad(kv, ((0, 0), (0, S), (0, 0)))
        kf_pad = _pad(ssm_k, ((0, 0), (0, S)))
        kv_f = (lambda x, axes=(-2,-1): torch.fft.rfft2(x.float(), dim=axes))(kv_pad[:, None, :, :], axes=(1, 2))
        kf_f = (lambda x, axes=(-2,-1): torch.fft.rfft2(x.float(), dim=axes))(kf_pad[:, None, :], axes=(1, 2))
        kf_f = (lambda x, *d: x.permute(*d))(kf_f, 1, 2, 0)
        y_f = kv_f * kf_f[None, :, :, :]
        y = (lambda x, s, axes=(-2,-1): torch.fft.irfft2(x, s=s, dim=axes).to(torch.bfloat16))(y_f, (1, L), axes=(1, 2))[:, 0, :S, :]
        y = y + kv * ssm_D[None, None, :]
        return q * y

    def _B_ref(x, w1, b1, w2, b2):
        B, S, D = x.shape
        h = _layernorm(x, axis=-1)
        u = torch.einsum("bsd,sf->bdf", h, w1) + b1
        u = _gelu(u)
        y = torch.einsum("bdf,fs->bds", u, w2) + b2
        return (lambda x, *d: x.permute(*d))(y, 0, 2, 1)

    x = A_q
    xn = _layernorm(x, axis=-1)
    return x + _A_ref(xn, A_k, A_v, A_shift_k, A_ssm_k, A_ssm_D) + _B_ref(xn, B_w1, B_b1, B_w2, B_b2)
```

```asm
; @launch kernel=prep_kernel grid=(1024,1,1) block=(256,1,1) lds=0
; @launch kernel=gemm1_kernel grid=(256,1,1) block=(768,1,1) lds=150016
; @launch kernel=gemm2_kernel grid=(256,1,1) block=(512,1,1) lds=155648
.amdgcn_target "amdgcn-amd-amdhsa--gfx950"
.text
.globl prep_kernel
.p2align 8
.type prep_kernel,@function
prep_kernel:
    s_cmp_ge_u32 s2, 1024
    s_cbranch_scc1 prep_done
    s_cmp_lt_u32 s2, 768
    s_cbranch_scc1 prep_notpf
    s_sub_u32 s2, s2, 768
    s_branch prep_pf
prep_notpf:
    s_load_dwordx4 s[4:7], s[0:1], 0
    s_load_dwordx4 s[8:11], s[0:1], 16
    s_load_dwordx2 s[12:13], s[0:1], 104
    s_add_u32 s3, s2, 512
    s_sub_u32 s14, s2, 256
    s_cmp_lt_u32 s2, 256
    s_cselect_b32 s2, s3, s14
    s_cmp_ge_u32 s2, 512
    s_cbranch_scc1 prep_kv
    v_and_b32 v1, 63, v0
    v_lshrrev_b32 v2, 6, v0
    s_lshl_b32 s3, s2, 2
    v_add_u32 v2, s3, v2
    v_lshlrev_b32 v3, 11, v2
    v_lshl_add_u32 v3, v1, 4, v3
    s_waitcnt lgkmcnt(0)
    s_mov_b32 s16, s4
    s_mov_b32 s17, s5
    s_mov_b32 s18, 4194304
    s_mov_b32 s19, 0x00020000
    s_mov_b32 s20, s12
    s_mov_b32 s21, s13
    s_mov_b32 s22, 4194304
    s_mov_b32 s23, 0x00020000
    s_add_u32 s24, s12, 4194304
    s_addc_u32 s25, s13, 0
    s_mov_b32 s26, 16384
    s_mov_b32 s27, 0x00020000
    buffer_load_dwordx4 v[4:7], v3, s[16:19], 0 offen
    buffer_load_dwordx4 v[8:11], v3, s[16:19], 0 offen offset:1024
    s_waitcnt vmcnt(0)
    v_lshlrev_b32 v16, 16, v4
    v_and_b32 v17, 0xffff0000, v4
    v_lshlrev_b32 v18, 16, v5
    v_and_b32 v19, 0xffff0000, v5
    v_lshlrev_b32 v20, 16, v6
    v_and_b32 v21, 0xffff0000, v6
    v_lshlrev_b32 v22, 16, v7
    v_and_b32 v23, 0xffff0000, v7
    v_lshlrev_b32 v24, 16, v8
    v_and_b32 v25, 0xffff0000, v8
    v_lshlrev_b32 v26, 16, v9
    v_and_b32 v27, 0xffff0000, v9
    v_lshlrev_b32 v28, 16, v10
    v_and_b32 v29, 0xffff0000, v10
    v_lshlrev_b32 v30, 16, v11
    v_and_b32 v31, 0xffff0000, v11
    s_mov_b32 s30, 0x3a800000
    s_mov_b32 s31, 0x3727c5ac
    s_add_u32 s40, s12, 4194304
    s_addc_u32 s41, s13, 0
    s_mov_b32 s42, 16384
    s_mov_b32 s43, 0x00020000
    v_add_f32 v12, v16, v17
    v_add_f32 v12, v12, v18
    v_add_f32 v12, v12, v19
    v_add_f32 v12, v12, v20
    v_add_f32 v12, v12, v21
    v_add_f32 v12, v12, v22
    v_add_f32 v12, v12, v23
    v_add_f32 v12, v12, v24
    v_add_f32 v12, v12, v25
    v_add_f32 v12, v12, v26
    v_add_f32 v12, v12, v27
    v_add_f32 v12, v12, v28
    v_add_f32 v12, v12, v29
    v_add_f32 v12, v12, v30
    v_add_f32 v12, v12, v31
    s_nop 1
    v_add_f32_dpp v12, v12, v12 row_shr:1 row_mask:0xf bank_mask:0xf bound_ctrl:0
    s_nop 1
    v_add_f32_dpp v12, v12, v12 row_shr:2 row_mask:0xf bank_mask:0xf bound_ctrl:0
    s_nop 1
    v_add_f32_dpp v12, v12, v12 row_shr:4 row_mask:0xf bank_mask:0xf bound_ctrl:0
    s_nop 1
    v_add_f32_dpp v12, v12, v12 row_shr:8 row_mask:0xf bank_mask:0xf bound_ctrl:0
    s_nop 1
    v_add_f32_dpp v12, v12, v12 row_bcast:15 row_mask:0xa bank_mask:0xf
    s_nop 1
    v_add_f32_dpp v12, v12, v12 row_bcast:31 row_mask:0xc bank_mask:0xf
    s_nop 1
    v_readlane_b32 s28, v12, 63
    s_nop 3
    v_mov_b32 v13, s28
    v_mul_f32 v13, s30, v13
    v_sub_f32 v32, v16, v13
    v_sub_f32 v33, v17, v13
    v_sub_f32 v34, v18, v13
    v_sub_f32 v35, v19, v13
    v_sub_f32 v36, v20, v13
    v_sub_f32 v37, v21, v13
    v_sub_f32 v38, v22, v13
    v_sub_f32 v39, v23, v13
    v_sub_f32 v40, v24, v13
    v_sub_f32 v41, v25, v13
    v_sub_f32 v42, v26, v13
    v_sub_f32 v43, v27, v13
    v_sub_f32 v44, v28, v13
    v_sub_f32 v45, v29, v13
    v_sub_f32 v46, v30, v13
    v_sub_f32 v47, v31, v13
    v_mul_f32 v12, v32, v32
    v_fmac_f32 v12, v33, v33
    v_fmac_f32 v12, v34, v34
    v_fmac_f32 v12, v35, v35
    v_fmac_f32 v12, v36, v36
    v_fmac_f32 v12, v37, v37
    v_fmac_f32 v12, v38, v38
    v_fmac_f32 v12, v39, v39
    v_fmac_f32 v12, v40, v40
    v_fmac_f32 v12, v41, v41
    v_fmac_f32 v12, v42, v42
    v_fmac_f32 v12, v43, v43
    v_fmac_f32 v12, v44, v44
    v_fmac_f32 v12, v45, v45
    v_fmac_f32 v12, v46, v46
    v_fmac_f32 v12, v47, v47
    s_nop 1
    v_add_f32_dpp v12, v12, v12 row_shr:1 row_mask:0xf bank_mask:0xf bound_ctrl:0
    s_nop 1
    v_add_f32_dpp v12, v12, v12 row_shr:2 row_mask:0xf bank_mask:0xf bound_ctrl:0
    s_nop 1
    v_add_f32_dpp v12, v12, v12 row_shr:4 row_mask:0xf bank_mask:0xf bound_ctrl:0
    s_nop 1
    v_add_f32_dpp v12, v12, v12 row_shr:8 row_mask:0xf bank_mask:0xf bound_ctrl:0
    s_nop 1
    v_add_f32_dpp v12, v12, v12 row_bcast:15 row_mask:0xa bank_mask:0xf
    s_nop 1
    v_add_f32_dpp v12, v12, v12 row_bcast:31 row_mask:0xc bank_mask:0xf
    s_nop 1
    v_readlane_b32 s28, v12, 63
    s_nop 3
    v_mov_b32 v14, s28
    v_mul_f32 v14, s30, v14
    v_cvt_pk_bf16_f32 v15, v13, v14
    v_lshlrev_b32 v13, 16, v15
    v_and_b32 v14, 0xffff0000, v15
    v_add_f32 v14, s31, v14
    v_cvt_pk_bf16_f32 v15, v14, v14
    v_lshlrev_b32 v14, 16, v15
    v_sqrt_f32 v14, v14
    s_nop 0
    v_cvt_pk_bf16_f32 v15, v14, v14
    v_lshlrev_b32 v14, 16, v15
    v_rcp_f32 v15, v14
    v_lshlrev_b32 v48, 3, v2
    v_cmp_eq_u32 vcc, 0, v1
    s_and_saveexec_b64 s[26:27], vcc
    v_mov_b32 v50, v13
    v_mov_b32 v51, v14
    buffer_store_dwordx2 v[50:51], v48, s[40:43], 0 offen
    s_mov_b64 exec, s[26:27]
    v_sub_f32 v16, v16, v13
    v_sub_f32 v17, v17, v13
    v_sub_f32 v18, v18, v13
    v_sub_f32 v19, v19, v13
    v_sub_f32 v20, v20, v13
    v_sub_f32 v21, v21, v13
    v_sub_f32 v22, v22, v13
    v_sub_f32 v23, v23, v13
    v_sub_f32 v24, v24, v13
    v_sub_f32 v25, v25, v13
    v_sub_f32 v26, v26, v13
    v_sub_f32 v27, v27, v13
    v_sub_f32 v28, v28, v13
    v_sub_f32 v29, v29, v13
    v_sub_f32 v30, v30, v13
    v_sub_f32 v31, v31, v13
    v_cvt_pk_bf16_f32 v12, v16, v17
    v_lshlrev_b32 v16, 16, v12
    v_and_b32 v17, 0xffff0000, v12
    v_cvt_pk_bf16_f32 v12, v18, v19
    v_lshlrev_b32 v18, 16, v12
    v_and_b32 v19, 0xffff0000, v12
    v_cvt_pk_bf16_f32 v12, v20, v21
    v_lshlrev_b32 v20, 16, v12
    v_and_b32 v21, 0xffff0000, v12
    v_cvt_pk_bf16_f32 v12, v22, v23
    v_lshlrev_b32 v22, 16, v12
    v_and_b32 v23, 0xffff0000, v12
    v_cvt_pk_bf16_f32 v12, v24, v25
    v_lshlrev_b32 v24, 16, v12
    v_and_b32 v25, 0xffff0000, v12
    v_cvt_pk_bf16_f32 v12, v26, v27
    v_lshlrev_b32 v26, 16, v12
    v_and_b32 v27, 0xffff0000, v12
    v_cvt_pk_bf16_f32 v12, v28, v29
    v_lshlrev_b32 v28, 16, v12
    v_and_b32 v29, 0xffff0000, v12
    v_cvt_pk_bf16_f32 v12, v30, v31
    v_lshlrev_b32 v30, 16, v12
    v_and_b32 v31, 0xffff0000, v12
    v_mul_f32 v32, v16, v15
    v_fma_f32 v16, -v32, v14, v16
    v_fmac_f32 v32, v16, v15
    v_mul_f32 v33, v17, v15
    v_fma_f32 v17, -v33, v14, v17
    v_fmac_f32 v33, v17, v15
    v_mul_f32 v34, v18, v15
    v_fma_f32 v18, -v34, v14, v18
    v_fmac_f32 v34, v18, v15
    v_mul_f32 v35, v19, v15
    v_fma_f32 v19, -v35, v14, v19
    v_fmac_f32 v35, v19, v15
    v_mul_f32 v36, v20, v15
    v_fma_f32 v20, -v36, v14, v20
    v_fmac_f32 v36, v20, v15
    v_mul_f32 v37, v21, v15
    v_fma_f32 v21, -v37, v14, v21
    v_fmac_f32 v37, v21, v15
    v_mul_f32 v38, v22, v15
    v_fma_f32 v22, -v38, v14, v22
    v_fmac_f32 v38, v22, v15
    v_mul_f32 v39, v23, v15
    v_fma_f32 v23, -v39, v14, v23
    v_fmac_f32 v39, v23, v15
    v_mul_f32 v40, v24, v15
    v_fma_f32 v24, -v40, v14, v24
    v_fmac_f32 v40, v24, v15
    v_mul_f32 v41, v25, v15
    v_fma_f32 v25, -v41, v14, v25
    v_fmac_f32 v41, v25, v15
    v_mul_f32 v42, v26, v15
    v_fma_f32 v26, -v42, v14, v26
    v_fmac_f32 v42, v26, v15
    v_mul_f32 v43, v27, v15
    v_fma_f32 v27, -v43, v14, v27
    v_fmac_f32 v43, v27, v15
    v_mul_f32 v44, v28, v15
    v_fma_f32 v28, -v44, v14, v28
    v_fmac_f32 v44, v28, v15
    v_mul_f32 v45, v29, v15
    v_fma_f32 v29, -v45, v14, v29
    v_fmac_f32 v45, v29, v15
    v_mul_f32 v46, v30, v15
    v_fma_f32 v30, -v46, v14, v30
    v_fmac_f32 v46, v30, v15
    v_mul_f32 v47, v31, v15
    v_fma_f32 v31, -v47, v14, v31
    v_fmac_f32 v47, v31, v15
    v_cvt_pk_bf16_f32 v4, v32, v33
    v_lshlrev_b32 v16, 16, v4
    v_and_b32 v17, 0xffff0000, v4
    v_cvt_pk_bf16_f32 v5, v34, v35
    v_lshlrev_b32 v18, 16, v5
    v_and_b32 v19, 0xffff0000, v5
    v_cvt_pk_bf16_f32 v6, v36, v37
    v_lshlrev_b32 v20, 16, v6
    v_and_b32 v21, 0xffff0000, v6
    v_cvt_pk_bf16_f32 v7, v38, v39
    v_lshlrev_b32 v22, 16, v7
    v_and_b32 v23, 0xffff0000, v7
    v_cvt_pk_bf16_f32 v8, v40, v41
    v_lshlrev_b32 v24, 16, v8
    v_and_b32 v25, 0xffff0000, v8
    v_cvt_pk_bf16_f32 v9, v42, v43
    v_lshlrev_b32 v26, 16, v9
    v_and_b32 v27, 0xffff0000, v9
    v_cvt_pk_bf16_f32 v10, v44, v45
    v_lshlrev_b32 v28, 16, v10
    v_and_b32 v29, 0xffff0000, v10
    v_cvt_pk_bf16_f32 v11, v46, v47
    v_lshlrev_b32 v30, 16, v11
    v_and_b32 v31, 0xffff0000, v11
    v_add_f32 v12, v16, v17
    v_add_f32 v12, v12, v18
    v_add_f32 v12, v12, v19
    v_add_f32 v12, v12, v20
    v_add_f32 v12, v12, v21
    v_add_f32 v12, v12, v22
    v_add_f32 v12, v12, v23
    v_add_f32 v12, v12, v24
    v_add_f32 v12, v12, v25
    v_add_f32 v12, v12, v26
    v_add_f32 v12, v12, v27
    v_add_f32 v12, v12, v28
    v_add_f32 v12, v12, v29
    v_add_f32 v12, v12, v30
    v_add_f32 v12, v12, v31
    s_nop 1
    v_add_f32_dpp v12, v12, v12 row_shr:1 row_mask:0xf bank_mask:0xf bound_ctrl:0
    s_nop 1
    v_add_f32_dpp v12, v12, v12 row_shr:2 row_mask:0xf bank_mask:0xf bound_ctrl:0
    s_nop 1
    v_add_f32_dpp v12, v12, v12 row_shr:4 row_mask:0xf bank_mask:0xf bound_ctrl:0
    s_nop 1
    v_add_f32_dpp v12, v12, v12 row_shr:8 row_mask:0xf bank_mask:0xf bound_ctrl:0
    s_nop 1
    v_add_f32_dpp v12, v12, v12 row_bcast:15 row_mask:0xa bank_mask:0xf
    s_nop 1
    v_add_f32_dpp v12, v12, v12 row_bcast:31 row_mask:0xc bank_mask:0xf
    s_nop 1
    v_readlane_b32 s28, v12, 63
    s_nop 3
    v_mov_b32 v13, s28
    v_mul_f32 v13, s30, v13
    v_sub_f32 v32, v16, v13
    v_sub_f32 v33, v17, v13
    v_sub_f32 v34, v18, v13
    v_sub_f32 v35, v19, v13
    v_sub_f32 v36, v20, v13
    v_sub_f32 v37, v21, v13
    v_sub_f32 v38, v22, v13
    v_sub_f32 v39, v23, v13
    v_sub_f32 v40, v24, v13
    v_sub_f32 v41, v25, v13
    v_sub_f32 v42, v26, v13
    v_sub_f32 v43, v27, v13
    v_sub_f32 v44, v28, v13
    v_sub_f32 v45, v29, v13
    v_sub_f32 v46, v30, v13
    v_sub_f32 v47, v31, v13
    v_mul_f32 v12, v32, v32
    v_fmac_f32 v12, v33, v33
    v_fmac_f32 v12, v34, v34
    v_fmac_f32 v12, v35, v35
    v_fmac_f32 v12, v36, v36
    v_fmac_f32 v12, v37, v37
    v_fmac_f32 v12, v38, v38
    v_fmac_f32 v12, v39, v39
    v_fmac_f32 v12, v40, v40
    v_fmac_f32 v12, v41, v41
    v_fmac_f32 v12, v42, v42
    v_fmac_f32 v12, v43, v43
    v_fmac_f32 v12, v44, v44
    v_fmac_f32 v12, v45, v45
    v_fmac_f32 v12, v46, v46
    v_fmac_f32 v12, v47, v47
    s_nop 1
    v_add_f32_dpp v12, v12, v12 row_shr:1 row_mask:0xf bank_mask:0xf bound_ctrl:0
    s_nop 1
    v_add_f32_dpp v12, v12, v12 row_shr:2 row_mask:0xf bank_mask:0xf bound_ctrl:0
    s_nop 1
    v_add_f32_dpp v12, v12, v12 row_shr:4 row_mask:0xf bank_mask:0xf bound_ctrl:0
    s_nop 1
    v_add_f32_dpp v12, v12, v12 row_shr:8 row_mask:0xf bank_mask:0xf bound_ctrl:0
    s_nop 1
    v_add_f32_dpp v12, v12, v12 row_bcast:15 row_mask:0xa bank_mask:0xf
    s_nop 1
    v_add_f32_dpp v12, v12, v12 row_bcast:31 row_mask:0xc bank_mask:0xf
    s_nop 1
    v_readlane_b32 s28, v12, 63
    s_nop 3
    v_mov_b32 v14, s28
    v_mul_f32 v14, s30, v14
    v_cvt_pk_bf16_f32 v15, v13, v14
    v_lshlrev_b32 v13, 16, v15
    v_and_b32 v14, 0xffff0000, v15
    v_add_f32 v14, s31, v14
    v_cvt_pk_bf16_f32 v15, v14, v14
    v_lshlrev_b32 v14, 16, v15
    v_sqrt_f32 v14, v14
    s_nop 0
    v_cvt_pk_bf16_f32 v15, v14, v14
    v_lshlrev_b32 v14, 16, v15
    v_rcp_f32 v15, v14
    v_sub_f32 v16, v16, v13
    v_sub_f32 v17, v17, v13
    v_sub_f32 v18, v18, v13
    v_sub_f32 v19, v19, v13
    v_sub_f32 v20, v20, v13
    v_sub_f32 v21, v21, v13
    v_sub_f32 v22, v22, v13
    v_sub_f32 v23, v23, v13
    v_sub_f32 v24, v24, v13
    v_sub_f32 v25, v25, v13
    v_sub_f32 v26, v26, v13
    v_sub_f32 v27, v27, v13
    v_sub_f32 v28, v28, v13
    v_sub_f32 v29, v29, v13
    v_sub_f32 v30, v30, v13
    v_sub_f32 v31, v31, v13
    v_cvt_pk_bf16_f32 v12, v16, v17
    v_lshlrev_b32 v16, 16, v12
    v_and_b32 v17, 0xffff0000, v12
    v_cvt_pk_bf16_f32 v12, v18, v19
    v_lshlrev_b32 v18, 16, v12
    v_and_b32 v19, 0xffff0000, v12
    v_cvt_pk_bf16_f32 v12, v20, v21
    v_lshlrev_b32 v20, 16, v12
    v_and_b32 v21, 0xffff0000, v12
    v_cvt_pk_bf16_f32 v12, v22, v23
    v_lshlrev_b32 v22, 16, v12
    v_and_b32 v23, 0xffff0000, v12
    v_cvt_pk_bf16_f32 v12, v24, v25
    v_lshlrev_b32 v24, 16, v12
    v_and_b32 v25, 0xffff0000, v12
    v_cvt_pk_bf16_f32 v12, v26, v27
    v_lshlrev_b32 v26, 16, v12
    v_and_b32 v27, 0xffff0000, v12
    v_cvt_pk_bf16_f32 v12, v28, v29
    v_lshlrev_b32 v28, 16, v12
    v_and_b32 v29, 0xffff0000, v12
    v_cvt_pk_bf16_f32 v12, v30, v31
    v_lshlrev_b32 v30, 16, v12
    v_and_b32 v31, 0xffff0000, v12
    v_mul_f32 v32, v16, v15
    v_fma_f32 v16, -v32, v14, v16
    v_fmac_f32 v32, v16, v15
    v_mul_f32 v33, v17, v15
    v_fma_f32 v17, -v33, v14, v17
    v_fmac_f32 v33, v17, v15
    v_mul_f32 v34, v18, v15
    v_fma_f32 v18, -v34, v14, v18
    v_fmac_f32 v34, v18, v15
    v_mul_f32 v35, v19, v15
    v_fma_f32 v19, -v35, v14, v19
    v_fmac_f32 v35, v19, v15
    v_mul_f32 v36, v20, v15
    v_fma_f32 v20, -v36, v14, v20
    v_fmac_f32 v36, v20, v15
    v_mul_f32 v37, v21, v15
    v_fma_f32 v21, -v37, v14, v21
    v_fmac_f32 v37, v21, v15
    v_mul_f32 v38, v22, v15
    v_fma_f32 v22, -v38, v14, v22
    v_fmac_f32 v38, v22, v15
    v_mul_f32 v39, v23, v15
    v_fma_f32 v23, -v39, v14, v23
    v_fmac_f32 v39, v23, v15
    v_mul_f32 v40, v24, v15
    v_fma_f32 v24, -v40, v14, v24
    v_fmac_f32 v40, v24, v15
    v_mul_f32 v41, v25, v15
    v_fma_f32 v25, -v41, v14, v25
    v_fmac_f32 v41, v25, v15
    v_mul_f32 v42, v26, v15
    v_fma_f32 v26, -v42, v14, v26
    v_fmac_f32 v42, v26, v15
    v_mul_f32 v43, v27, v15
    v_fma_f32 v27, -v43, v14, v27
    v_fmac_f32 v43, v27, v15
    v_mul_f32 v44, v28, v15
    v_fma_f32 v28, -v44, v14, v28
    v_fmac_f32 v44, v28, v15
    v_mul_f32 v45, v29, v15
    v_fma_f32 v29, -v45, v14, v29
    v_fmac_f32 v45, v29, v15
    v_mul_f32 v46, v30, v15
    v_fma_f32 v30, -v46, v14, v30
    v_fmac_f32 v46, v30, v15
    v_mul_f32 v47, v31, v15
    v_fma_f32 v31, -v47, v14, v31
    v_fmac_f32 v47, v31, v15
    v_cvt_pk_bf16_f32 v4, v32, v33
    v_lshlrev_b32 v16, 16, v4
    v_and_b32 v17, 0xffff0000, v4
    v_cvt_pk_bf16_f32 v5, v34, v35
    v_lshlrev_b32 v18, 16, v5
    v_and_b32 v19, 0xffff0000, v5
    v_cvt_pk_bf16_f32 v6, v36, v37
    v_lshlrev_b32 v20, 16, v6
    v_and_b32 v21, 0xffff0000, v6
    v_cvt_pk_bf16_f32 v7, v38, v39
    v_lshlrev_b32 v22, 16, v7
    v_and_b32 v23, 0xffff0000, v7
    v_cvt_pk_bf16_f32 v8, v40, v41
    v_lshlrev_b32 v24, 16, v8
    v_and_b32 v25, 0xffff0000, v8
    v_cvt_pk_bf16_f32 v9, v42, v43
    v_lshlrev_b32 v26, 16, v9
    v_and_b32 v27, 0xffff0000, v9
    v_cvt_pk_bf16_f32 v10, v44, v45
    v_lshlrev_b32 v28, 16, v10
    v_and_b32 v29, 0xffff0000, v10
    v_cvt_pk_bf16_f32 v11, v46, v47
    v_lshlrev_b32 v30, 16, v11
    v_and_b32 v31, 0xffff0000, v11
    buffer_store_dwordx4 v[4:7], v3, s[20:23], 0 offen
    buffer_store_dwordx4 v[8:11], v3, s[20:23], 0 offen offset:1024
    s_endpgm
prep_kv:
    s_sub_u32 s3, s2, 512
    s_and_b32 s14, s3, 15
    s_lshr_b32 s15, s3, 4
    v_and_b32 v1, 7, v0
    v_lshrrev_b32 v2, 3, v0
    s_lshl_b32 s14, s14, 7
    s_lshl_b32 s15, s15, 6
    v_lshl_add_u32 v2, v2, 2, s14
    v_lshl_add_u32 v1, v1, 3, s15
    v_lshlrev_b32 v3, 11, v2
    v_lshl_add_u32 v3, v1, 1, v3
    s_waitcnt lgkmcnt(0)
    s_mov_b32 s16, s6
    s_mov_b32 s17, s7
    s_mov_b32 s18, 4194304
    s_mov_b32 s19, 0x00020000
    s_mov_b32 s20, s8
    s_mov_b32 s21, s9
    s_mov_b32 s22, 4194304
    s_mov_b32 s23, 0x00020000
    s_mov_b32 s24, s10
    s_mov_b32 s25, s11
    s_mov_b32 s26, 8192
    s_mov_b32 s27, 0x00020000
    s_add_u32 s28, s12, 8388608
    s_addc_u32 s29, s13, 0
    s_mov_b32 s30, 4194304
    s_mov_b32 s31, 0x00020000
    v_add_u32 v4, 0xffffe800, v3
    v_add_u32 v5, 0xfffff000, v3
    v_add_u32 v6, 0xfffff800, v3
    v_add_u32 v7, 0x0, v3
    v_add_u32 v8, 0x800, v3
    v_add_u32 v9, 0x1000, v3
    v_add_u32 v10, 0x1800, v3
    buffer_load_dwordx4 v[16:19], v4, s[16:19], 0 offen nt
    buffer_load_dwordx4 v[20:23], v5, s[16:19], 0 offen nt
    buffer_load_dwordx4 v[24:27], v6, s[16:19], 0 offen nt
    buffer_load_dwordx4 v[28:31], v7, s[16:19], 0 offen nt
    buffer_load_dwordx4 v[32:35], v8, s[16:19], 0 offen nt
    buffer_load_dwordx4 v[36:39], v9, s[16:19], 0 offen nt
    buffer_load_dwordx4 v[40:43], v10, s[16:19], 0 offen nt
    buffer_load_dwordx4 v[44:47], v7, s[20:23], 0 offen nt
    buffer_load_dwordx4 v[48:51], v8, s[20:23], 0 offen nt
    buffer_load_dwordx4 v[52:55], v9, s[20:23], 0 offen nt
    buffer_load_dwordx4 v[56:59], v10, s[20:23], 0 offen nt
    v_lshlrev_b32 v11, 3, v1
    buffer_load_dwordx4 v[60:63], v11, s[24:27], 0 offen offset:0
    buffer_load_dwordx4 v[64:67], v11, s[24:27], 0 offen offset:16
    buffer_load_dwordx4 v[68:71], v11, s[24:27], 0 offen offset:32
    buffer_load_dwordx4 v[72:75], v11, s[24:27], 0 offen offset:48
    v_lshlrev_b32 v12, 12, v1
    v_xor_b32 v13, 4, v2
    v_lshl_add_u32 v12, v13, 1, v12
    s_waitcnt vmcnt(0)
    v_lshlrev_b32 v80, 16, v16
    v_lshlrev_b32 v81, 16, v20
    v_lshlrev_b32 v82, 16, v24
    v_lshlrev_b32 v83, 16, v28
    v_lshlrev_b32 v84, 16, v32
    v_lshlrev_b32 v85, 16, v36
    v_lshlrev_b32 v86, 16, v40
    v_lshlrev_b32 v88, 16, v44
    v_lshlrev_b32 v89, 16, v48
    v_lshlrev_b32 v90, 16, v52
    v_lshlrev_b32 v91, 16, v56
    v_lshlrev_b32 v92, 16, v60
    v_and_b32 v93, 0xffff0000, v60
    v_lshlrev_b32 v94, 16, v61
    v_and_b32 v95, 0xffff0000, v61
    v_mul_f32 v96, v80, v95
    v_mul_f32 v97, v81, v95
    v_mul_f32 v98, v82, v95
    v_mul_f32 v99, v83, v95
    v_cvt_pk_bf16_f32 v13, v96, v97
    v_lshlrev_b32 v96, 16, v13
    v_and_b32 v97, 0xffff0000, v13
    v_cvt_pk_bf16_f32 v13, v98, v99
    v_lshlrev_b32 v98, 16, v13
    v_and_b32 v99, 0xffff0000, v13
    v_mul_f32 v100, v81, v94
    v_mul_f32 v101, v82, v94
    v_mul_f32 v102, v83, v94
    v_mul_f32 v103, v84, v94
    v_cvt_pk_bf16_f32 v13, v100, v101
    v_lshlrev_b32 v100, 16, v13
    v_and_b32 v101, 0xffff0000, v13
    v_cvt_pk_bf16_f32 v13, v102, v103
    v_lshlrev_b32 v102, 16, v13
    v_and_b32 v103, 0xffff0000, v13
    v_mul_f32 v104, v82, v93
    v_mul_f32 v105, v83, v93
    v_mul_f32 v106, v84, v93
    v_mul_f32 v107, v85, v93
    v_cvt_pk_bf16_f32 v13, v104, v105
    v_lshlrev_b32 v104, 16, v13
    v_and_b32 v105, 0xffff0000, v13
    v_cvt_pk_bf16_f32 v13, v106, v107
    v_lshlrev_b32 v106, 16, v13
    v_and_b32 v107, 0xffff0000, v13
    v_mul_f32 v108, v83, v92
    v_mul_f32 v109, v84, v92
    v_mul_f32 v110, v85, v92
    v_mul_f32 v111, v86, v92
    v_cvt_pk_bf16_f32 v13, v108, v109
    v_lshlrev_b32 v108, 16, v13
    v_and_b32 v109, 0xffff0000, v13
    v_cvt_pk_bf16_f32 v13, v110, v111
    v_lshlrev_b32 v110, 16, v13
    v_and_b32 v111, 0xffff0000, v13
    v_add_f32 v96, v96, v100
    v_add_f32 v97, v97, v101
    v_add_f32 v98, v98, v102
    v_add_f32 v99, v99, v103
    v_cvt_pk_bf16_f32 v13, v96, v97
    v_lshlrev_b32 v96, 16, v13
    v_and_b32 v97, 0xffff0000, v13
    v_cvt_pk_bf16_f32 v13, v98, v99
    v_lshlrev_b32 v98, 16, v13
    v_and_b32 v99, 0xffff0000, v13
    v_add_f32 v96, v96, v104
    v_add_f32 v97, v97, v105
    v_add_f32 v98, v98, v106
    v_add_f32 v99, v99, v107
    v_cvt_pk_bf16_f32 v13, v96, v97
    v_lshlrev_b32 v96, 16, v13
    v_and_b32 v97, 0xffff0000, v13
    v_cvt_pk_bf16_f32 v13, v98, v99
    v_lshlrev_b32 v98, 16, v13
    v_and_b32 v99, 0xffff0000, v13
    v_add_f32 v96, v96, v108
    v_add_f32 v97, v97, v109
    v_add_f32 v98, v98, v110
    v_add_f32 v99, v99, v111
    v_cvt_pk_bf16_f32 v13, v96, v97
    v_lshlrev_b32 v96, 16, v13
    v_and_b32 v97, 0xffff0000, v13
    v_cvt_pk_bf16_f32 v13, v98, v99
    v_lshlrev_b32 v98, 16, v13
    v_and_b32 v99, 0xffff0000, v13
    v_mul_f32 v96, v96, v88
    v_mul_f32 v97, v97, v89
    v_mul_f32 v98, v98, v90
    v_mul_f32 v99, v99, v91
    v_cvt_pk_bf16_f32 v112, v99, v98
    v_cvt_pk_bf16_f32 v113, v97, v96
    buffer_store_dwordx2 v[112:113], v12, s[28:31], 0 offen
    v_add_u32 v12, 0x1000, v12
    v_and_b32 v80, 0xffff0000, v16
    v_and_b32 v81, 0xffff0000, v20
    v_and_b32 v82, 0xffff0000, v24
    v_and_b32 v83, 0xffff0000, v28
    v_and_b32 v84, 0xffff0000, v32
    v_and_b32 v85, 0xffff0000, v36
    v_and_b32 v86, 0xffff0000, v40
    v_and_b32 v88, 0xffff0000, v44
    v_and_b32 v89, 0xffff0000, v48
    v_and_b32 v90, 0xffff0000, v52
    v_and_b32 v91, 0xffff0000, v56
    v_lshlrev_b32 v92, 16, v62
    v_and_b32 v93, 0xffff0000, v62
    v_lshlrev_b32 v94, 16, v63
    v_and_b32 v95, 0xffff0000, v63
    v_mul_f32 v96, v80, v95
    v_mul_f32 v97, v81, v95
    v_mul_f32 v98, v82, v95
    v_mul_f32 v99, v83, v95
    v_cvt_pk_bf16_f32 v13, v96, v97
    v_lshlrev_b32 v96, 16, v13
    v_and_b32 v97, 0xffff0000, v13
    v_cvt_pk_bf16_f32 v13, v98, v99
    v_lshlrev_b32 v98, 16, v13
    v_and_b32 v99, 0xffff0000, v13
    v_mul_f32 v100, v81, v94
    v_mul_f32 v101, v82, v94
    v_mul_f32 v102, v83, v94
    v_mul_f32 v103, v84, v94
    v_cvt_pk_bf16_f32 v13, v100, v101
    v_lshlrev_b32 v100, 16, v13
    v_and_b32 v101, 0xffff0000, v13
    v_cvt_pk_bf16_f32 v13, v102, v103
    v_lshlrev_b32 v102, 16, v13
    v_and_b32 v103, 0xffff0000, v13
    v_mul_f32 v104, v82, v93
    v_mul_f32 v105, v83, v93
    v_mul_f32 v106, v84, v93
    v_mul_f32 v107, v85, v93
    v_cvt_pk_bf16_f32 v13, v104, v105
    v_lshlrev_b32 v104, 16, v13
    v_and_b32 v105, 0xffff0000, v13
    v_cvt_pk_bf16_f32 v13, v106, v107
    v_lshlrev_b32 v106, 16, v13
    v_and_b32 v107, 0xffff0000, v13
    v_mul_f32 v108, v83, v92
    v_mul_f32 v109, v84, v92
    v_mul_f32 v110, v85, v92
    v_mul_f32 v111, v86, v92
    v_cvt_pk_bf16_f32 v13, v108, v109
    v_lshlrev_b32 v108, 16, v13
    v_and_b32 v109, 0xffff0000, v13
    v_cvt_pk_bf16_f32 v13, v110, v111
    v_lshlrev_b32 v110, 16, v13
    v_and_b32 v111, 0xffff0000, v13
    v_add_f32 v96, v96, v100
    v_add_f32 v97, v97, v101
    v_add_f32 v98, v98, v102
    v_add_f32 v99, v99, v103
    v_cvt_pk_bf16_f32 v13, v96, v97
    v_lshlrev_b32 v96, 16, v13
    v_and_b32 v97, 0xffff0000, v13
    v_cvt_pk_bf16_f32 v13, v98, v99
    v_lshlrev_b32 v98, 16, v13
    v_and_b32 v99, 0xffff0000, v13
    v_add_f32 v96, v96, v104
    v_add_f32 v97, v97, v105
    v_add_f32 v98, v98, v106
    v_add_f32 v99, v99, v107
    v_cvt_pk_bf16_f32 v13, v96, v97
    v_lshlrev_b32 v96, 16, v13
    v_and_b32 v97, 0xffff0000, v13
    v_cvt_pk_bf16_f32 v13, v98, v99
    v_lshlrev_b32 v98, 16, v13
    v_and_b32 v99, 0xffff0000, v13
    v_add_f32 v96, v96, v108
    v_add_f32 v97, v97, v109
    v_add_f32 v98, v98, v110
    v_add_f32 v99, v99, v111
    v_cvt_pk_bf16_f32 v13, v96, v97
    v_lshlrev_b32 v96, 16, v13
    v_and_b32 v97, 0xffff0000, v13
    v_cvt_pk_bf16_f32 v13, v98, v99
    v_lshlrev_b32 v98, 16, v13
    v_and_b32 v99, 0xffff0000, v13
    v_mul_f32 v96, v96, v88
    v_mul_f32 v97, v97, v89
    v_mul_f32 v98, v98, v90
    v_mul_f32 v99, v99, v91
    v_cvt_pk_bf16_f32 v114, v99, v98
    v_cvt_pk_bf16_f32 v115, v97, v96
    buffer_store_dwordx2 v[114:115], v12, s[28:31], 0 offen
    v_add_u32 v12, 0x1000, v12
    v_lshlrev_b32 v80, 16, v17
    v_lshlrev_b32 v81, 16, v21
    v_lshlrev_b32 v82, 16, v25
    v_lshlrev_b32 v83, 16, v29
    v_lshlrev_b32 v84, 16, v33
    v_lshlrev_b32 v85, 16, v37
    v_lshlrev_b32 v86, 16, v41
    v_lshlrev_b32 v88, 16, v45
    v_lshlrev_b32 v89, 16, v49
    v_lshlrev_b32 v90, 16, v53
    v_lshlrev_b32 v91, 16, v57
    v_lshlrev_b32 v92, 16, v64
    v_and_b32 v93, 0xffff0000, v64
    v_lshlrev_b32 v94, 16, v65
    v_and_b32 v95, 0xffff0000, v65
    v_mul_f32 v96, v80, v95
    v_mul_f32 v97, v81, v95
    v_mul_f32 v98, v82, v95
    v_mul_f32 v99, v83, v95
    v_cvt_pk_bf16_f32 v13, v96, v97
    v_lshlrev_b32 v96, 16, v13
    v_and_b32 v97, 0xffff0000, v13
    v_cvt_pk_bf16_f32 v13, v98, v99
    v_lshlrev_b32 v98, 16, v13
    v_and_b32 v99, 0xffff0000, v13
    v_mul_f32 v100, v81, v94
    v_mul_f32 v101, v82, v94
    v_mul_f32 v102, v83, v94
    v_mul_f32 v103, v84, v94
    v_cvt_pk_bf16_f32 v13, v100, v101
    v_lshlrev_b32 v100, 16, v13
    v_and_b32 v101, 0xffff0000, v13
    v_cvt_pk_bf16_f32 v13, v102, v103
    v_lshlrev_b32 v102, 16, v13
    v_and_b32 v103, 0xffff0000, v13
    v_mul_f32 v104, v82, v93
    v_mul_f32 v105, v83, v93
    v_mul_f32 v106, v84, v93
    v_mul_f32 v107, v85, v93
    v_cvt_pk_bf16_f32 v13, v104, v105
    v_lshlrev_b32 v104, 16, v13
    v_and_b32 v105, 0xffff0000, v13
    v_cvt_pk_bf16_f32 v13, v106, v107
    v_lshlrev_b32 v106, 16, v13
    v_and_b32 v107, 0xffff0000, v13
    v_mul_f32 v108, v83, v92
    v_mul_f32 v109, v84, v92
    v_mul_f32 v110, v85, v92
    v_mul_f32 v111, v86, v92
    v_cvt_pk_bf16_f32 v13, v108, v109
    v_lshlrev_b32 v108, 16, v13
    v_and_b32 v109, 0xffff0000, v13
    v_cvt_pk_bf16_f32 v13, v110, v111
    v_lshlrev_b32 v110, 16, v13
    v_and_b32 v111, 0xffff0000, v13
    v_add_f32 v96, v96, v100
    v_add_f32 v97, v97, v101
    v_add_f32 v98, v98, v102
    v_add_f32 v99, v99, v103
    v_cvt_pk_bf16_f32 v13, v96, v97
    v_lshlrev_b32 v96, 16, v13
    v_and_b32 v97, 0xffff0000, v13
    v_cvt_pk_bf16_f32 v13, v98, v99
    v_lshlrev_b32 v98, 16, v13
    v_and_b32 v99, 0xffff0000, v13
    v_add_f32 v96, v96, v104
    v_add_f32 v97, v97, v105
    v_add_f32 v98, v98, v106
    v_add_f32 v99, v99, v107
    v_cvt_pk_bf16_f32 v13, v96, v97
    v_lshlrev_b32 v96, 16, v13
    v_and_b32 v97, 0xffff0000, v13
    v_cvt_pk_bf16_f32 v13, v98, v99
    v_lshlrev_b32 v98, 16, v13
    v_and_b32 v99, 0xffff0000, v13
    v_add_f32 v96, v96, v108
    v_add_f32 v97, v97, v109
    v_add_f32 v98, v98, v110
    v_add_f32 v99, v99, v111
    v_cvt_pk_bf16_f32 v13, v96, v97
    v_lshlrev_b32 v96, 16, v13
    v_and_b32 v97, 0xffff0000, v13
    v_cvt_pk_bf16_f32 v13, v98, v99
    v_lshlrev_b32 v98, 16, v13
    v_and_b32 v99, 0xffff0000, v13
    v_mul_f32 v96, v96, v88
    v_mul_f32 v97, v97, v89
    v_mul_f32 v98, v98, v90
    v_mul_f32 v99, v99, v91
    v_cvt_pk_bf16_f32 v112, v99, v98
    v_cvt_pk_bf16_f32 v113, v97, v96
    buffer_store_dwordx2 v[112:113], v12, s[28:31], 0 offen
    v_add_u32 v12, 0x1000, v12
    v_and_b32 v80, 0xffff0000, v17
    v_and_b32 v81, 0xffff0000, v21
    v_and_b32 v82, 0xffff0000, v25
    v_and_b32 v83, 0xffff0000, v29
    v_and_b32 v84, 0xffff0000, v33
    v_and_b32 v85, 0xffff0000, v37
    v_and_b32 v86, 0xffff0000, v41
    v_and_b32 v88, 0xffff0000, v45
    v_and_b32 v89, 0xffff0000, v49
    v_and_b32 v90, 0xffff0000, v53
    v_and_b32 v91, 0xffff0000, v57
    v_lshlrev_b32 v92, 16, v66
    v_and_b32 v93, 0xffff0000, v66
    v_lshlrev_b32 v94, 16, v67
    v_and_b32 v95, 0xffff0000, v67
    v_mul_f32 v96, v80, v95
    v_mul_f32 v97, v81, v95
    v_mul_f32 v98, v82, v95
    v_mul_f32 v99, v83, v95
    v_cvt_pk_bf16_f32 v13, v96, v97
    v_lshlrev_b32 v96, 16, v13
    v_and_b32 v97, 0xffff0000, v13
    v_cvt_pk_bf16_f32 v13, v98, v99
    v_lshlrev_b32 v98, 16, v13
    v_and_b32 v99, 0xffff0000, v13
    v_mul_f32 v100, v81, v94
    v_mul_f32 v101, v82, v94
    v_mul_f32 v102, v83, v94
    v_mul_f32 v103, v84, v94
    v_cvt_pk_bf16_f32 v13, v100, v101
    v_lshlrev_b32 v100, 16, v13
    v_and_b32 v101, 0xffff0000, v13
    v_cvt_pk_bf16_f32 v13, v102, v103
    v_lshlrev_b32 v102, 16, v13
    v_and_b32 v103, 0xffff0000, v13
    v_mul_f32 v104, v82, v93
    v_mul_f32 v105, v83, v93
    v_mul_f32 v106, v84, v93
    v_mul_f32 v107, v85, v93
    v_cvt_pk_bf16_f32 v13, v104, v105
    v_lshlrev_b32 v104, 16, v13
    v_and_b32 v105, 0xffff0000, v13
    v_cvt_pk_bf16_f32 v13, v106, v107
    v_lshlrev_b32 v106, 16, v13
    v_and_b32 v107, 0xffff0000, v13
    v_mul_f32 v108, v83, v92
    v_mul_f32 v109, v84, v92
    v_mul_f32 v110, v85, v92
    v_mul_f32 v111, v86, v92
    v_cvt_pk_bf16_f32 v13, v108, v109
    v_lshlrev_b32 v108, 16, v13
    v_and_b32 v109, 0xffff0000, v13
    v_cvt_pk_bf16_f32 v13, v110, v111
    v_lshlrev_b32 v110, 16, v13
    v_and_b32 v111, 0xffff0000, v13
    v_add_f32 v96, v96, v100
    v_add_f32 v97, v97, v101
    v_add_f32 v98, v98, v102
    v_add_f32 v99, v99, v103
    v_cvt_pk_bf16_f32 v13, v96, v97
    v_lshlrev_b32 v96, 16, v13
    v_and_b32 v97, 0xffff0000, v13
    v_cvt_pk_bf16_f32 v13, v98, v99
    v_lshlrev_b32 v98, 16, v13
    v_and_b32 v99, 0xffff0000, v13
    v_add_f32 v96, v96, v104
    v_add_f32 v97, v97, v105
    v_add_f32 v98, v98, v106
    v_add_f32 v99, v99, v107
    v_cvt_pk_bf16_f32 v13, v96, v97
    v_lshlrev_b32 v96, 16, v13
    v_and_b32 v97, 0xffff0000, v13
    v_cvt_pk_bf16_f32 v13, v98, v99
    v_lshlrev_b32 v98, 16, v13
    v_and_b32 v99, 0xffff0000, v13
    v_add_f32 v96, v96, v108
    v_add_f32 v97, v97, v109
    v_add_f32 v98, v98, v110
    v_add_f32 v99, v99, v111
    v_cvt_pk_bf16_f32 v13, v96, v97
    v_lshlrev_b32 v96, 16, v13
    v_and_b32 v97, 0xffff0000, v13
    v_cvt_pk_bf16_f32 v13, v98, v99
    v_lshlrev_b32 v98, 16, v13
    v_and_b32 v99, 0xffff0000, v13
    v_mul_f32 v96, v96, v88
    v_mul_f32 v97, v97, v89
    v_mul_f32 v98, v98, v90
    v_mul_f32 v99, v99, v91
    v_cvt_pk_bf16_f32 v114, v99, v98
    v_cvt_pk_bf16_f32 v115, v97, v96
    buffer_store_dwordx2 v[114:115], v12, s[28:31], 0 offen
    v_add_u32 v12, 0x1000, v12
    v_lshlrev_b32 v80, 16, v18
    v_lshlrev_b32 v81, 16, v22
    v_lshlrev_b32 v82, 16, v26
    v_lshlrev_b32 v83, 16, v30
    v_lshlrev_b32 v84, 16, v34
    v_lshlrev_b32 v85, 16, v38
    v_lshlrev_b32 v86, 16, v42
    v_lshlrev_b32 v88, 16, v46
    v_lshlrev_b32 v89, 16, v50
    v_lshlrev_b32 v90, 16, v54
    v_lshlrev_b32 v91, 16, v58
    v_lshlrev_b32 v92, 16, v68
    v_and_b32 v93, 0xffff0000, v68
    v_lshlrev_b32 v94, 16, v69
    v_and_b32 v95, 0xffff0000, v69
    v_mul_f32 v96, v80, v95
    v_mul_f32 v97, v81, v95
    v_mul_f32 v98, v82, v95
    v_mul_f32 v99, v83, v95
    v_cvt_pk_bf16_f32 v13, v96, v97
    v_lshlrev_b32 v96, 16, v13
    v_and_b32 v97, 0xffff0000, v13
    v_cvt_pk_bf16_f32 v13, v98, v99
    v_lshlrev_b32 v98, 16, v13
    v_and_b32 v99, 0xffff0000, v13
    v_mul_f32 v100, v81, v94
    v_mul_f32 v101, v82, v94
    v_mul_f32 v102, v83, v94
    v_mul_f32 v103, v84, v94
    v_cvt_pk_bf16_f32 v13, v100, v101
    v_lshlrev_b32 v100, 16, v13
    v_and_b32 v101, 0xffff0000, v13
    v_cvt_pk_bf16_f32 v13, v102, v103
    v_lshlrev_b32 v102, 16, v13
    v_and_b32 v103, 0xffff0000, v13
    v_mul_f32 v104, v82, v93
    v_mul_f32 v105, v83, v93
    v_mul_f32 v106, v84, v93
    v_mul_f32 v107, v85, v93
    v_cvt_pk_bf16_f32 v13, v104, v105
    v_lshlrev_b32 v104, 16, v13
    v_and_b32 v105, 0xffff0000, v13
    v_cvt_pk_bf16_f32 v13, v106, v107
    v_lshlrev_b32 v106, 16, v13
    v_and_b32 v107, 0xffff0000, v13
    v_mul_f32 v108, v83, v92
    v_mul_f32 v109, v84, v92
    v_mul_f32 v110, v85, v92
    v_mul_f32 v111, v86, v92
    v_cvt_pk_bf16_f32 v13, v108, v109
    v_lshlrev_b32 v108, 16, v13
    v_and_b32 v109, 0xffff0000, v13
    v_cvt_pk_bf16_f32 v13, v110, v111
    v_lshlrev_b32 v110, 16, v13
    v_and_b32 v111, 0xffff0000, v13
    v_add_f32 v96, v96, v100
    v_add_f32 v97, v97, v101
    v_add_f32 v98, v98, v102
    v_add_f32 v99, v99, v103
    v_cvt_pk_bf16_f32 v13, v96, v97
    v_lshlrev_b32 v96, 16, v13
    v_and_b32 v97, 0xffff0000, v13
    v_cvt_pk_bf16_f32 v13, v98, v99
    v_lshlrev_b32 v98, 16, v13
    v_and_b32 v99, 0xffff0000, v13
    v_add_f32 v96, v96, v104
    v_add_f32 v97, v97, v105
    v_add_f32 v98, v98, v106
    v_add_f32 v99, v99, v107
    v_cvt_pk_bf16_f32 v13, v96, v97
    v_lshlrev_b32 v96, 16, v13
    v_and_b32 v97, 0xffff0000, v13
    v_cvt_pk_bf16_f32 v13, v98, v99
    v_lshlrev_b32 v98, 16, v13
    v_and_b32 v99, 0xffff0000, v13
    v_add_f32 v96, v96, v108
    v_add_f32 v97, v97, v109
    v_add_f32 v98, v98, v110
    v_add_f32 v99, v99, v111
    v_cvt_pk_bf16_f32 v13, v96, v97
    v_lshlrev_b32 v96, 16, v13
    v_and_b32 v97, 0xffff0000, v13
    v_cvt_pk_bf16_f32 v13, v98, v99
    v_lshlrev_b32 v98, 16, v13
    v_and_b32 v99, 0xffff0000, v13
    v_mul_f32 v96, v96, v88
    v_mul_f32 v97, v97, v89
    v_mul_f32 v98, v98, v90
    v_mul_f32 v99, v99, v91
    v_cvt_pk_bf16_f32 v112, v99, v98
    v_cvt_pk_bf16_f32 v113, v97, v96
    buffer_store_dwordx2 v[112:113], v12, s[28:31], 0 offen
    v_add_u32 v12, 0x1000, v12
    v_and_b32 v80, 0xffff0000, v18
    v_and_b32 v81, 0xffff0000, v22
    v_and_b32 v82, 0xffff0000, v26
    v_and_b32 v83, 0xffff0000, v30
    v_and_b32 v84, 0xffff0000, v34
    v_and_b32 v85, 0xffff0000, v38
    v_and_b32 v86, 0xffff0000, v42
    v_and_b32 v88, 0xffff0000, v46
    v_and_b32 v89, 0xffff0000, v50
    v_and_b32 v90, 0xffff0000, v54
    v_and_b32 v91, 0xffff0000, v58
    v_lshlrev_b32 v92, 16, v70
    v_and_b32 v93, 0xffff0000, v70
    v_lshlrev_b32 v94, 16, v71
    v_and_b32 v95, 0xffff0000, v71
    v_mul_f32 v96, v80, v95
    v_mul_f32 v97, v81, v95
    v_mul_f32 v98, v82, v95
    v_mul_f32 v99, v83, v95
    v_cvt_pk_bf16_f32 v13, v96, v97
    v_lshlrev_b32 v96, 16, v13
    v_and_b32 v97, 0xffff0000, v13
    v_cvt_pk_bf16_f32 v13, v98, v99
    v_lshlrev_b32 v98, 16, v13
    v_and_b32 v99, 0xffff0000, v13
    v_mul_f32 v100, v81, v94
    v_mul_f32 v101, v82, v94
    v_mul_f32 v102, v83, v94
    v_mul_f32 v103, v84, v94
    v_cvt_pk_bf16_f32 v13, v100, v101
    v_lshlrev_b32 v100, 16, v13
    v_and_b32 v101, 0xffff0000, v13
    v_cvt_pk_bf16_f32 v13, v102, v103
    v_lshlrev_b32 v102, 16, v13
    v_and_b32 v103, 0xffff0000, v13
    v_mul_f32 v104, v82, v93
    v_mul_f32 v105, v83, v93
    v_mul_f32 v106, v84, v93
    v_mul_f32 v107, v85, v93
    v_cvt_pk_bf16_f32 v13, v104, v105
    v_lshlrev_b32 v104, 16, v13
    v_and_b32 v105, 0xffff0000, v13
    v_cvt_pk_bf16_f32 v13, v106, v107
    v_lshlrev_b32 v106, 16, v13
    v_and_b32 v107, 0xffff0000, v13
    v_mul_f32 v108, v83, v92
    v_mul_f32 v109, v84, v92
    v_mul_f32 v110, v85, v92
    v_mul_f32 v111, v86, v92
    v_cvt_pk_bf16_f32 v13, v108, v109
    v_lshlrev_b32 v108, 16, v13
    v_and_b32 v109, 0xffff0000, v13
    v_cvt_pk_bf16_f32 v13, v110, v111
    v_lshlrev_b32 v110, 16, v13
    v_and_b32 v111, 0xffff0000, v13
    v_add_f32 v96, v96, v100
    v_add_f32 v97, v97, v101
    v_add_f32 v98, v98, v102
    v_add_f32 v99, v99, v103
    v_cvt_pk_bf16_f32 v13, v96, v97
    v_lshlrev_b32 v96, 16, v13
    v_and_b32 v97, 0xffff0000, v13
    v_cvt_pk_bf16_f32 v13, v98, v99
    v_lshlrev_b32 v98, 16, v13
    v_and_b32 v99, 0xffff0000, v13
    v_add_f32 v96, v96, v104
    v_add_f32 v97, v97, v105
    v_add_f32 v98, v98, v106
    v_add_f32 v99, v99, v107
    v_cvt_pk_bf16_f32 v13, v96, v97
    v_lshlrev_b32 v96, 16, v13
    v_and_b32 v97, 0xffff0000, v13
    v_cvt_pk_bf16_f32 v13, v98, v99
    v_lshlrev_b32 v98, 16, v13
    v_and_b32 v99, 0xffff0000, v13
    v_add_f32 v96, v96, v108
    v_add_f32 v97, v97, v109
    v_add_f32 v98, v98, v110
    v_add_f32 v99, v99, v111
    v_cvt_pk_bf16_f32 v13, v96, v97
    v_lshlrev_b32 v96, 16, v13
    v_and_b32 v97, 0xffff0000, v13
    v_cvt_pk_bf16_f32 v13, v98, v99
    v_lshlrev_b32 v98, 16, v13
    v_and_b32 v99, 0xffff0000, v13
    v_mul_f32 v96, v96, v88
    v_mul_f32 v97, v97, v89
    v_mul_f32 v98, v98, v90
    v_mul_f32 v99, v99, v91
    v_cvt_pk_bf16_f32 v114, v99, v98
    v_cvt_pk_bf16_f32 v115, v97, v96
    buffer_store_dwordx2 v[114:115], v12, s[28:31], 0 offen
    v_add_u32 v12, 0x1000, v12
    v_lshlrev_b32 v80, 16, v19
    v_lshlrev_b32 v81, 16, v23
    v_lshlrev_b32 v82, 16, v27
    v_lshlrev_b32 v83, 16, v31
    v_lshlrev_b32 v84, 16, v35
    v_lshlrev_b32 v85, 16, v39
    v_lshlrev_b32 v86, 16, v43
    v_lshlrev_b32 v88, 16, v47
    v_lshlrev_b32 v89, 16, v51
    v_lshlrev_b32 v90, 16, v55
    v_lshlrev_b32 v91, 16, v59
    v_lshlrev_b32 v92, 16, v72
    v_and_b32 v93, 0xffff0000, v72
    v_lshlrev_b32 v94, 16, v73
    v_and_b32 v95, 0xffff0000, v73
    v_mul_f32 v96, v80, v95
    v_mul_f32 v97, v81, v95
    v_mul_f32 v98, v82, v95
    v_mul_f32 v99, v83, v95
    v_cvt_pk_bf16_f32 v13, v96, v97
    v_lshlrev_b32 v96, 16, v13
    v_and_b32 v97, 0xffff0000, v13
    v_cvt_pk_bf16_f32 v13, v98, v99
    v_lshlrev_b32 v98, 16, v13
    v_and_b32 v99, 0xffff0000, v13
    v_mul_f32 v100, v81, v94
    v_mul_f32 v101, v82, v94
    v_mul_f32 v102, v83, v94
    v_mul_f32 v103, v84, v94
    v_cvt_pk_bf16_f32 v13, v100, v101
    v_lshlrev_b32 v100, 16, v13
    v_and_b32 v101, 0xffff0000, v13
    v_cvt_pk_bf16_f32 v13, v102, v103
    v_lshlrev_b32 v102, 16, v13
    v_and_b32 v103, 0xffff0000, v13
    v_mul_f32 v104, v82, v93
    v_mul_f32 v105, v83, v93
    v_mul_f32 v106, v84, v93
    v_mul_f32 v107, v85, v93
    v_cvt_pk_bf16_f32 v13, v104, v105
    v_lshlrev_b32 v104, 16, v13
    v_and_b32 v105, 0xffff0000, v13
    v_cvt_pk_bf16_f32 v13, v106, v107
    v_lshlrev_b32 v106, 16, v13
    v_and_b32 v107, 0xffff0000, v13
    v_mul_f32 v108, v83, v92
    v_mul_f32 v109, v84, v92
    v_mul_f32 v110, v85, v92
    v_mul_f32 v111, v86, v92
    v_cvt_pk_bf16_f32 v13, v108, v109
    v_lshlrev_b32 v108, 16, v13
    v_and_b32 v109, 0xffff0000, v13
    v_cvt_pk_bf16_f32 v13, v110, v111
    v_lshlrev_b32 v110, 16, v13
    v_and_b32 v111, 0xffff0000, v13
    v_add_f32 v96, v96, v100
    v_add_f32 v97, v97, v101
    v_add_f32 v98, v98, v102
    v_add_f32 v99, v99, v103
    v_cvt_pk_bf16_f32 v13, v96, v97
    v_lshlrev_b32 v96, 16, v13
    v_and_b32 v97, 0xffff0000, v13
    v_cvt_pk_bf16_f32 v13, v98, v99
    v_lshlrev_b32 v98, 16, v13
    v_and_b32 v99, 0xffff0000, v13
    v_add_f32 v96, v96, v104
    v_add_f32 v97, v97, v105
    v_add_f32 v98, v98, v106
    v_add_f32 v99, v99, v107
    v_cvt_pk_bf16_f32 v13, v96, v97
    v_lshlrev_b32 v96, 16, v13
    v_and_b32 v97, 0xffff0000, v13
    v_cvt_pk_bf16_f32 v13, v98, v99
    v_lshlrev_b32 v98, 16, v13
    v_and_b32 v99, 0xffff0000, v13
    v_add_f32 v96, v96, v108
    v_add_f32 v97, v97, v109
    v_add_f32 v98, v98, v110
    v_add_f32 v99, v99, v111
    v_cvt_pk_bf16_f32 v13, v96, v97
    v_lshlrev_b32 v96, 16, v13
    v_and_b32 v97, 0xffff0000, v13
    v_cvt_pk_bf16_f32 v13, v98, v99
    v_lshlrev_b32 v98, 16, v13
    v_and_b32 v99, 0xffff0000, v13
    v_mul_f32 v96, v96, v88
    v_mul_f32 v97, v97, v89
    v_mul_f32 v98, v98, v90
    v_mul_f32 v99, v99, v91
    v_cvt_pk_bf16_f32 v112, v99, v98
    v_cvt_pk_bf16_f32 v113, v97, v96
    buffer_store_dwordx2 v[112:113], v12, s[28:31], 0 offen
    v_add_u32 v12, 0x1000, v12
    v_and_b32 v80, 0xffff0000, v19
    v_and_b32 v81, 0xffff0000, v23
    v_and_b32 v82, 0xffff0000, v27
    v_and_b32 v83, 0xffff0000, v31
    v_and_b32 v84, 0xffff0000, v35
    v_and_b32 v85, 0xffff0000, v39
    v_and_b32 v86, 0xffff0000, v43
    v_and_b32 v88, 0xffff0000, v47
    v_and_b32 v89, 0xffff0000, v51
    v_and_b32 v90, 0xffff0000, v55
    v_and_b32 v91, 0xffff0000, v59
    v_lshlrev_b32 v92, 16, v74
    v_and_b32 v93, 0xffff0000, v74
    v_lshlrev_b32 v94, 16, v75
    v_and_b32 v95, 0xffff0000, v75
    v_mul_f32 v96, v80, v95
    v_mul_f32 v97, v81, v95
    v_mul_f32 v98, v82, v95
    v_mul_f32 v99, v83, v95
    v_cvt_pk_bf16_f32 v13, v96, v97
    v_lshlrev_b32 v96, 16, v13
    v_and_b32 v97, 0xffff0000, v13
    v_cvt_pk_bf16_f32 v13, v98, v99
    v_lshlrev_b32 v98, 16, v13
    v_and_b32 v99, 0xffff0000, v13
    v_mul_f32 v100, v81, v94
    v_mul_f32 v101, v82, v94
    v_mul_f32 v102, v83, v94
    v_mul_f32 v103, v84, v94
    v_cvt_pk_bf16_f32 v13, v100, v101
    v_lshlrev_b32 v100, 16, v13
    v_and_b32 v101, 0xffff0000, v13
    v_cvt_pk_bf16_f32 v13, v102, v103
    v_lshlrev_b32 v102, 16, v13
    v_and_b32 v103, 0xffff0000, v13
    v_mul_f32 v104, v82, v93
    v_mul_f32 v105, v83, v93
    v_mul_f32 v106, v84, v93
    v_mul_f32 v107, v85, v93
    v_cvt_pk_bf16_f32 v13, v104, v105
    v_lshlrev_b32 v104, 16, v13
    v_and_b32 v105, 0xffff0000, v13
    v_cvt_pk_bf16_f32 v13, v106, v107
    v_lshlrev_b32 v106, 16, v13
    v_and_b32 v107, 0xffff0000, v13
    v_mul_f32 v108, v83, v92
    v_mul_f32 v109, v84, v92
    v_mul_f32 v110, v85, v92
    v_mul_f32 v111, v86, v92
    v_cvt_pk_bf16_f32 v13, v108, v109
    v_lshlrev_b32 v108, 16, v13
    v_and_b32 v109, 0xffff0000, v13
    v_cvt_pk_bf16_f32 v13, v110, v111
    v_lshlrev_b32 v110, 16, v13
    v_and_b32 v111, 0xffff0000, v13
    v_add_f32 v96, v96, v100
    v_add_f32 v97, v97, v101
    v_add_f32 v98, v98, v102
    v_add_f32 v99, v99, v103
    v_cvt_pk_bf16_f32 v13, v96, v97
    v_lshlrev_b32 v96, 16, v13
    v_and_b32 v97, 0xffff0000, v13
    v_cvt_pk_bf16_f32 v13, v98, v99
    v_lshlrev_b32 v98, 16, v13
    v_and_b32 v99, 0xffff0000, v13
    v_add_f32 v96, v96, v104
    v_add_f32 v97, v97, v105
    v_add_f32 v98, v98, v106
    v_add_f32 v99, v99, v107
    v_cvt_pk_bf16_f32 v13, v96, v97
    v_lshlrev_b32 v96, 16, v13
    v_and_b32 v97, 0xffff0000, v13
    v_cvt_pk_bf16_f32 v13, v98, v99
    v_lshlrev_b32 v98, 16, v13
    v_and_b32 v99, 0xffff0000, v13
    v_add_f32 v96, v96, v108
    v_add_f32 v97, v97, v109
    v_add_f32 v98, v98, v110
    v_add_f32 v99, v99, v111
    v_cvt_pk_bf16_f32 v13, v96, v97
    v_lshlrev_b32 v96, 16, v13
    v_and_b32 v97, 0xffff0000, v13
    v_cvt_pk_bf16_f32 v13, v98, v99
    v_lshlrev_b32 v98, 16, v13
    v_and_b32 v99, 0xffff0000, v13
    v_mul_f32 v96, v96, v88
    v_mul_f32 v97, v97, v89
    v_mul_f32 v98, v98, v90
    v_mul_f32 v99, v99, v91
    v_cvt_pk_bf16_f32 v114, v99, v98
    v_cvt_pk_bf16_f32 v115, v97, v96
    buffer_store_dwordx2 v[114:115], v12, s[28:31], 0 offen
    v_add_u32 v12, 0x1000, v12
    s_endpgm
prep_pf:
    s_load_dwordx2 s[4:5], s[0:1], 56
    s_load_dwordx2 s[6:7], s[0:1], 32
    s_mul_i32 s3, s2, 57344
    v_lshlrev_b32 v1, 4, v0
    v_add_u32 v1, s3, v1
    s_waitcnt lgkmcnt(0)
    s_mov_b32 s8, s4
    s_mov_b32 s9, s5
    s_mov_b32 s10, 14680064
    s_mov_b32 s11, 0x00020000
    s_mov_b32 s12, s6
    s_mov_b32 s13, s7
    s_mov_b32 s14, 4194304
    s_mov_b32 s15, 0x00020000
    s_mul_i32 s3, s2, 16384
    v_lshlrev_b32 v2, 4, v0
    v_add_u32 v2, s3, v2
    s_mov_b32 s16, 0
    buffer_load_dwordx4 v[8:11], v2, s[12:15], s16 offen
    s_mov_b32 s16, 4096
    buffer_load_dwordx4 v[16:19], v2, s[12:15], s16 offen
    s_mov_b32 s16, 8192
    buffer_load_dwordx4 v[24:27], v2, s[12:15], s16 offen
    s_mov_b32 s16, 12288
    buffer_load_dwordx4 v[32:35], v2, s[12:15], s16 offen
    s_mov_b32 s16, 0
    buffer_load_dwordx4 v[4:7], v1, s[8:11], s16 offen
    s_mov_b32 s16, 4096
    buffer_load_dwordx4 v[12:15], v1, s[8:11], s16 offen
    s_mov_b32 s16, 8192
    buffer_load_dwordx4 v[20:23], v1, s[8:11], s16 offen
    s_mov_b32 s16, 12288
    buffer_load_dwordx4 v[28:31], v1, s[8:11], s16 offen
    s_mov_b32 s16, 16384
    buffer_load_dwordx4 v[36:39], v1, s[8:11], s16 offen
    s_mov_b32 s16, 20480
    buffer_load_dwordx4 v[44:47], v1, s[8:11], s16 offen
    s_mov_b32 s16, 24576
    buffer_load_dwordx4 v[52:55], v1, s[8:11], s16 offen
    s_mov_b32 s16, 28672
    buffer_load_dwordx4 v[60:63], v1, s[8:11], s16 offen
    s_mov_b32 s16, 32768
    buffer_load_dwordx4 v[4:7], v1, s[8:11], s16 offen
    s_mov_b32 s16, 36864
    buffer_load_dwordx4 v[12:15], v1, s[8:11], s16 offen
    s_mov_b32 s16, 40960
    buffer_load_dwordx4 v[20:23], v1, s[8:11], s16 offen
    s_mov_b32 s16, 45056
    buffer_load_dwordx4 v[28:31], v1, s[8:11], s16 offen
    s_mov_b32 s16, 49152
    buffer_load_dwordx4 v[36:39], v1, s[8:11], s16 offen
    s_mov_b32 s16, 53248
    buffer_load_dwordx4 v[44:47], v1, s[8:11], s16 offen
prep_done:
    s_endpgm
.globl gemm1_kernel
.p2align 8
.type gemm1_kernel,@function
gemm1_kernel:
    s_cmp_ge_u32 s2, 256
    s_cbranch_scc1 g1_done
    s_load_dwordx4 s[4:7], s[0:1], 56
    s_load_dwordx2 s[8:9], s[0:1], 104
    s_load_dwordx4 s[68:71], s[0:1], 32
    s_load_dwordx2 s[74:75], s[0:1], 72
    s_and_b32 s10, s2, 7
    s_lshr_b32 s11, s2, 3
    s_mul_i32 s12, s11, 37
    s_lshr_b32 s12, s12, 8
    s_mul_i32 s13, s12, 7
    s_sub_u32 s13, s11, s13
    s_and_b32 s14, s10, 3
    s_mul_i32 s14, s14, 7
    s_add_u32 s14, s14, s13
    s_lshr_b32 s15, s10, 2
    s_lshl_b32 s15, s15, 2
    s_add_u32 s15, s15, s12
    v_and_b32 v1, 63, v0
    v_lshrrev_b32 v2, 6, v0
    s_nop 0
    v_readfirstlane_b32 s16, v2
    s_waitcnt lgkmcnt(0)
    s_cmp_ge_u32 s2, 224
    s_cbranch_scc1 g1_extra
    s_mov_b32 s20, s4
    s_mov_b32 s21, s5
    s_mov_b32 s22, 14680064
    s_mov_b32 s23, 0x00020000
    s_mov_b32 s24, s8
    s_mov_b32 s25, s9
    s_mov_b32 s26, 4194304
    s_mov_b32 s27, 0x00020000
    v_lshrrev_b32 v3, 4, v1
    s_cmp_ge_u32 s16, 8
    s_cbranch_scc1 g1_convw
    s_cmp_ge_u32 s16, 4
    s_cbranch_scc1 g1_loader
    s_add_u32 s28, s8, 16777216
    s_addc_u32 s29, s9, 0
    s_mov_b32 s30, 7340032
    s_mov_b32 s31, 0x00020000
    s_mov_b32 s32, s6
    s_mov_b32 s33, s7
    s_mov_b32 s34, 7168
    s_mov_b32 s35, 0x00020000
    s_and_b32 s17, s16, 1
    s_bfe_u32 s18, s16, 0x10001
    s_lshr_b32 s19, s16, 2
    s_lshl_b32 s37, s14, 7
    s_lshl_b32 s38, s17, 6
    s_add_u32 s37, s37, s38
    s_lshl_b32 s38, s19, 5
    s_add_u32 s37, s37, s38
    v_lshl_add_u32 v24, v3, 2, s37
    v_lshlrev_b32 v24, 1, v24
    buffer_load_dwordx2 v[28:29], v24, s[32:35], 0 offen offset:0
    buffer_load_dwordx2 v[30:31], v24, s[32:35], 0 offen offset:32
    s_mul_i32 s37, s15, 112
    s_lshl_b32 s38, s14, 2
    s_add_u32 s37, s37, s38
    s_lshl_b32 s38, s17, 1
    s_add_u32 s37, s37, s38
    s_add_u32 s37, s37, s19
    s_lshl_b32 s37, s37, 3
    s_lshl_b32 s38, s18, 2
    s_add_u32 s37, s37, s38
    s_lshl_b32 s37, s37, 10
    v_lshl_add_u32 v25, v1, 4, s37
    s_and_b32 s37, s16, 3
    s_lshl_b32 s37, s37, 13
    v_lshl_add_u32 v26, v1, 4, s37
    s_mov_b32 s42, 0xc0135761
    s_mov_b32 s43, 0xc0135761
    s_mov_b32 s44, 0xbdd2d3e8
    s_mov_b32 s45, 0xbdd2d3e8
    v_bfe_u32 v4, v1, 2, 2
    v_and_b32 v5, 3, v1
    v_and_b32 v6, 1, v3
    v_lshl_or_b32 v6, v6, 2, v4
    v_lshl_add_u32 v7, v3, 3, v4
    v_lshlrev_b32 v7, 8, v7
    v_lshl_add_u32 v7, v5, 3, v7
    s_lshl_b32 s19, s17, 2
    s_lshl_b32 s36, s18, 2
    s_add_u32 s37, s19, 0
    v_xor_b32 v8, s37, v6
    v_lshl_add_u32 v8, v8, 5, v7
    s_add_u32 s37, s36, 0
    v_xor_b32 v12, s37, v6
    v_lshl_add_u32 v12, v12, 5, v7
    v_add_u32 v12, 0x4000, v12
    v_mov_b32 v16, v8
    v_mov_b32 v20, v12
    s_add_u32 s37, s19, 1
    v_xor_b32 v9, s37, v6
    v_lshl_add_u32 v9, v9, 5, v7
    s_add_u32 s37, s36, 1
    v_xor_b32 v13, s37, v6
    v_lshl_add_u32 v13, v13, 5, v7
    v_add_u32 v13, 0x4000, v13
    v_mov_b32 v17, v9
    v_mov_b32 v21, v13
    s_add_u32 s37, s19, 2
    v_xor_b32 v10, s37, v6
    v_lshl_add_u32 v10, v10, 5, v7
    s_add_u32 s37, s36, 2
    v_xor_b32 v14, s37, v6
    v_lshl_add_u32 v14, v14, 5, v7
    v_add_u32 v14, 0x4000, v14
    v_mov_b32 v18, v10
    v_mov_b32 v22, v14
    s_add_u32 s37, s19, 3
    v_xor_b32 v11, s37, v6
    v_lshl_add_u32 v11, v11, 5, v7
    s_add_u32 s37, s36, 3
    v_xor_b32 v15, s37, v6
    v_lshl_add_u32 v15, v15, 5, v7
    v_add_u32 v15, 0x4000, v15
    v_mov_b32 v19, v11
    v_mov_b32 v23, v15
    v_mov_b32 v96, 0
    v_mov_b32 v97, 0
    v_mov_b32 v98, 0
    v_mov_b32 v99, 0
    v_mov_b32 v100, 0
    v_mov_b32 v101, 0
    v_mov_b32 v102, 0
    v_mov_b32 v103, 0
    v_mov_b32 v104, 0
    v_mov_b32 v105, 0
    v_mov_b32 v106, 0
    v_mov_b32 v107, 0
    v_mov_b32 v108, 0
    v_mov_b32 v109, 0
    v_mov_b32 v110, 0
    v_mov_b32 v111, 0
    v_mov_b32 v112, 0
    v_mov_b32 v113, 0
    v_mov_b32 v114, 0
    v_mov_b32 v115, 0
    v_mov_b32 v116, 0
    v_mov_b32 v117, 0
    v_mov_b32 v118, 0
    v_mov_b32 v119, 0
    v_mov_b32 v120, 0
    v_mov_b32 v121, 0
    v_mov_b32 v122, 0
    v_mov_b32 v123, 0
    v_mov_b32 v124, 0
    v_mov_b32 v125, 0
    v_mov_b32 v126, 0
    v_mov_b32 v127, 0
    v_mov_b32 v128, 0
    v_mov_b32 v129, 0
    v_mov_b32 v130, 0
    v_mov_b32 v131, 0
    v_mov_b32 v132, 0
    v_mov_b32 v133, 0
    v_mov_b32 v134, 0
    v_mov_b32 v135, 0
    v_mov_b32 v136, 0
    v_mov_b32 v137, 0
    v_mov_b32 v138, 0
    v_mov_b32 v139, 0
    v_mov_b32 v140, 0
    v_mov_b32 v141, 0
    v_mov_b32 v142, 0
    v_mov_b32 v143, 0
    v_mov_b32 v144, 0
    v_mov_b32 v145, 0
    v_mov_b32 v146, 0
    v_mov_b32 v147, 0
    v_mov_b32 v148, 0
    v_mov_b32 v149, 0
    v_mov_b32 v150, 0
    v_mov_b32 v151, 0
    v_mov_b32 v152, 0
    v_mov_b32 v153, 0
    v_mov_b32 v154, 0
    v_mov_b32 v155, 0
    v_mov_b32 v156, 0
    v_mov_b32 v157, 0
    v_mov_b32 v158, 0
    v_mov_b32 v159, 0
    s_mov_b32 s39, 0
    s_mov_b32 s40, 0
    s_barrier
    ds_read_b64_tr_b16 v[32:33], v16 offset:0
    ds_read_b64_tr_b16 v[34:35], v16 offset:1024
    ds_read_b64_tr_b16 v[48:49], v20 offset:0
    ds_read_b64_tr_b16 v[50:51], v20 offset:1024
    ds_read_b64_tr_b16 v[36:37], v17 offset:0
    ds_read_b64_tr_b16 v[38:39], v17 offset:1024
    ds_read_b64_tr_b16 v[52:53], v21 offset:0
    ds_read_b64_tr_b16 v[54:55], v21 offset:1024
    ds_read_b64_tr_b16 v[40:41], v18 offset:0
    ds_read_b64_tr_b16 v[42:43], v18 offset:1024
    ds_read_b64_tr_b16 v[56:57], v22 offset:0
    ds_read_b64_tr_b16 v[58:59], v22 offset:1024
    ds_read_b64_tr_b16 v[44:45], v19 offset:0
    ds_read_b64_tr_b16 v[46:47], v19 offset:1024
    ds_read_b64_tr_b16 v[60:61], v23 offset:0
    ds_read_b64_tr_b16 v[62:63], v23 offset:1024
g1_cloop:
    s_waitcnt lgkmcnt(0)
    v_mfma_f32_16x16x32_bf16 v[96:99], v[32:35], v[48:51], v[96:99]
    ds_read_b64_tr_b16 v[64:65], v16 offset:8192
    ds_read_b64_tr_b16 v[66:67], v16 offset:9216
    v_mfma_f32_16x16x32_bf16 v[100:103], v[32:35], v[52:55], v[100:103]
    ds_read_b64_tr_b16 v[80:81], v20 offset:8192
    ds_read_b64_tr_b16 v[82:83], v20 offset:9216
    v_mfma_f32_16x16x32_bf16 v[104:107], v[32:35], v[56:59], v[104:107]
    ds_read_b64_tr_b16 v[68:69], v17 offset:8192
    ds_read_b64_tr_b16 v[70:71], v17 offset:9216
    v_mfma_f32_16x16x32_bf16 v[108:111], v[32:35], v[60:63], v[108:111]
    ds_read_b64_tr_b16 v[84:85], v21 offset:8192
    ds_read_b64_tr_b16 v[86:87], v21 offset:9216
    v_mfma_f32_16x16x32_bf16 v[112:115], v[36:39], v[48:51], v[112:115]
    ds_read_b64_tr_b16 v[72:73], v18 offset:8192
    ds_read_b64_tr_b16 v[74:75], v18 offset:9216
    v_mfma_f32_16x16x32_bf16 v[116:119], v[36:39], v[52:55], v[116:119]
    ds_read_b64_tr_b16 v[88:89], v22 offset:8192
    ds_read_b64_tr_b16 v[90:91], v22 offset:9216
    v_mfma_f32_16x16x32_bf16 v[120:123], v[36:39], v[56:59], v[120:123]
    ds_read_b64_tr_b16 v[76:77], v19 offset:8192
    ds_read_b64_tr_b16 v[78:79], v19 offset:9216
    v_mfma_f32_16x16x32_bf16 v[124:127], v[36:39], v[60:63], v[124:127]
    ds_read_b64_tr_b16 v[92:93], v23 offset:8192
    ds_read_b64_tr_b16 v[94:95], v23 offset:9216
    v_mfma_f32_16x16x32_bf16 v[128:131], v[40:43], v[48:51], v[128:131]
    v_mfma_f32_16x16x32_bf16 v[132:135], v[40:43], v[52:55], v[132:135]
    v_mfma_f32_16x16x32_bf16 v[136:139], v[40:43], v[56:59], v[136:139]
    v_mfma_f32_16x16x32_bf16 v[140:143], v[40:43], v[60:63], v[140:143]
    v_mfma_f32_16x16x32_bf16 v[144:147], v[44:47], v[48:51], v[144:147]
    v_mfma_f32_16x16x32_bf16 v[148:151], v[44:47], v[52:55], v[148:151]
    v_mfma_f32_16x16x32_bf16 v[152:155], v[44:47], v[56:59], v[152:155]
    v_mfma_f32_16x16x32_bf16 v[156:159], v[44:47], v[60:63], v[156:159]
    s_waitcnt lgkmcnt(0)
    s_barrier
    s_add_u32 s39, s39, 32768
    s_cmp_eq_u32 s39, 98304
    s_cselect_b32 s39, 0, s39
    v_mfma_f32_16x16x32_bf16 v[96:99], v[64:67], v[80:83], v[96:99]
    v_add_u32 v16, s39, v8
    v_add_u32 v20, s39, v12
    v_add_u32 v17, s39, v9
    v_add_u32 v21, s39, v13
    v_add_u32 v18, s39, v10
    v_add_u32 v22, s39, v14
    v_add_u32 v19, s39, v11
    v_add_u32 v23, s39, v15
    v_mfma_f32_16x16x32_bf16 v[100:103], v[64:67], v[84:87], v[100:103]
    ds_read_b64_tr_b16 v[32:33], v16 offset:0
    ds_read_b64_tr_b16 v[34:35], v16 offset:1024
    v_mfma_f32_16x16x32_bf16 v[104:107], v[64:67], v[88:91], v[104:107]
    ds_read_b64_tr_b16 v[48:49], v20 offset:0
    ds_read_b64_tr_b16 v[50:51], v20 offset:1024
    v_mfma_f32_16x16x32_bf16 v[108:111], v[64:67], v[92:95], v[108:111]
    ds_read_b64_tr_b16 v[36:37], v17 offset:0
    ds_read_b64_tr_b16 v[38:39], v17 offset:1024
    v_mfma_f32_16x16x32_bf16 v[112:115], v[68:71], v[80:83], v[112:115]
    ds_read_b64_tr_b16 v[52:53], v21 offset:0
    ds_read_b64_tr_b16 v[54:55], v21 offset:1024
    v_mfma_f32_16x16x32_bf16 v[116:119], v[68:71], v[84:87], v[116:119]
    ds_read_b64_tr_b16 v[40:41], v18 offset:0
    ds_read_b64_tr_b16 v[42:43], v18 offset:1024
    v_mfma_f32_16x16x32_bf16 v[120:123], v[68:71], v[88:91], v[120:123]
    ds_read_b64_tr_b16 v[56:57], v22 offset:0
    ds_read_b64_tr_b16 v[58:59], v22 offset:1024
    v_mfma_f32_16x16x32_bf16 v[124:127], v[68:71], v[92:95], v[124:127]
    ds_read_b64_tr_b16 v[44:45], v19 offset:0
    ds_read_b64_tr_b16 v[46:47], v19 offset:1024
    v_mfma_f32_16x16x32_bf16 v[128:131], v[72:75], v[80:83], v[128:131]
    ds_read_b64_tr_b16 v[60:61], v23 offset:0
    ds_read_b64_tr_b16 v[62:63], v23 offset:1024
    v_mfma_f32_16x16x32_bf16 v[132:135], v[72:75], v[84:87], v[132:135]
    v_mfma_f32_16x16x32_bf16 v[136:139], v[72:75], v[88:91], v[136:139]
    v_mfma_f32_16x16x32_bf16 v[140:143], v[72:75], v[92:95], v[140:143]
    v_mfma_f32_16x16x32_bf16 v[144:147], v[76:79], v[80:83], v[144:147]
    v_mfma_f32_16x16x32_bf16 v[148:151], v[76:79], v[84:87], v[148:151]
    v_mfma_f32_16x16x32_bf16 v[152:155], v[76:79], v[88:91], v[152:155]
    v_mfma_f32_16x16x32_bf16 v[156:159], v[76:79], v[92:95], v[156:159]
    s_add_u32 s40, s40, 1
    s_cmp_lt_u32 s40, 32
    s_cbranch_scc1 g1_cloop
    s_waitcnt lgkmcnt(0)
    s_nop 7
    ds_write_b128 v26, v[128:131] offset:0
    ds_write_b128 v26, v[132:135] offset:1024
    ds_write_b128 v26, v[136:139] offset:2048
    ds_write_b128 v26, v[140:143] offset:3072
    ds_write_b128 v26, v[144:147] offset:4096
    ds_write_b128 v26, v[148:151] offset:5120
    ds_write_b128 v26, v[152:155] offset:6144
    ds_write_b128 v26, v[156:159] offset:7168
    s_waitcnt lgkmcnt(0) vmcnt(0)
    s_barrier
    v_mov_b32 v56, s42
    v_mov_b32 v57, s42
    v_mov_b32 v58, 1.0
    v_mov_b32 v59, 1.0
    v_lshlrev_b32 v32, 16, v28
    v_and_b32 v33, 0xffff0000, v28
    v_lshlrev_b32 v34, 16, v29
    v_and_b32 v35, 0xffff0000, v29
    v_lshlrev_b32 v36, 16, v30
    v_and_b32 v37, 0xffff0000, v30
    v_lshlrev_b32 v38, 16, v31
    v_and_b32 v39, 0xffff0000, v31
    v_cvt_pk_bf16_f32 v40, v96, v97
    v_cvt_pk_bf16_f32 v41, v98, v99
    v_lshlrev_b32 v96, 16, v40
    v_and_b32 v97, 0xffff0000, v40
    v_lshlrev_b32 v98, 16, v41
    v_and_b32 v99, 0xffff0000, v41
    v_pk_add_f32 v[96:97], v[96:97], v[32:33]
    v_pk_add_f32 v[98:99], v[98:99], v[34:35]
    v_cvt_pk_bf16_f32 v40, v96, v97
    v_cvt_pk_bf16_f32 v41, v98, v99
    v_lshlrev_b32 v96, 16, v40
    v_and_b32 v97, 0xffff0000, v40
    v_lshlrev_b32 v98, 16, v41
    v_and_b32 v99, 0xffff0000, v41
    v_pk_mul_f32 v[40:41], v[96:97], v[96:97]
    v_pk_mul_f32 v[42:43], v[98:99], v[98:99]
    v_pk_fma_f32 v[40:41], v[40:41], s[44:45], v[56:57]
    v_pk_fma_f32 v[42:43], v[42:43], s[44:45], v[56:57]
    v_pk_mul_f32 v[40:41], v[40:41], v[96:97]
    v_pk_mul_f32 v[42:43], v[42:43], v[98:99]
    v_exp_f32 v40, v40
    v_exp_f32 v41, v41
    v_exp_f32 v42, v42
    v_exp_f32 v43, v43
    s_nop 0
    v_pk_add_f32 v[40:41], v[40:41], v[58:59]
    v_pk_add_f32 v[42:43], v[42:43], v[58:59]
    v_rcp_f32 v40, v40
    v_rcp_f32 v41, v41
    v_rcp_f32 v42, v42
    v_rcp_f32 v43, v43
    s_nop 0
    v_pk_mul_f32 v[96:97], v[96:97], v[40:41]
    v_pk_mul_f32 v[98:99], v[98:99], v[42:43]
    v_cvt_pk_bf16_f32 v48, v96, v97
    v_cvt_pk_bf16_f32 v49, v98, v99
    v_cvt_pk_bf16_f32 v44, v112, v113
    v_cvt_pk_bf16_f32 v45, v114, v115
    v_lshlrev_b32 v112, 16, v44
    v_and_b32 v113, 0xffff0000, v44
    v_lshlrev_b32 v114, 16, v45
    v_and_b32 v115, 0xffff0000, v45
    v_pk_add_f32 v[112:113], v[112:113], v[36:37]
    v_pk_add_f32 v[114:115], v[114:115], v[38:39]
    v_cvt_pk_bf16_f32 v44, v112, v113
    v_cvt_pk_bf16_f32 v45, v114, v115
    v_lshlrev_b32 v112, 16, v44
    v_and_b32 v113, 0xffff0000, v44
    v_lshlrev_b32 v114, 16, v45
    v_and_b32 v115, 0xffff0000, v45
    v_pk_mul_f32 v[44:45], v[112:113], v[112:113]
    v_pk_mul_f32 v[46:47], v[114:115], v[114:115]
    v_pk_fma_f32 v[44:45], v[44:45], s[44:45], v[56:57]
    v_pk_fma_f32 v[46:47], v[46:47], s[44:45], v[56:57]
    v_pk_mul_f32 v[44:45], v[44:45], v[112:113]
    v_pk_mul_f32 v[46:47], v[46:47], v[114:115]
    v_exp_f32 v44, v44
    v_exp_f32 v45, v45
    v_exp_f32 v46, v46
    v_exp_f32 v47, v47
    s_nop 0
    v_pk_add_f32 v[44:45], v[44:45], v[58:59]
    v_pk_add_f32 v[46:47], v[46:47], v[58:59]
    v_rcp_f32 v44, v44
    v_rcp_f32 v45, v45
    v_rcp_f32 v46, v46
    v_rcp_f32 v47, v47
    s_nop 0
    v_pk_mul_f32 v[112:113], v[112:113], v[44:45]
    v_pk_mul_f32 v[114:115], v[114:115], v[46:47]
    v_cvt_pk_bf16_f32 v50, v112, v113
    v_cvt_pk_bf16_f32 v51, v114, v115
    buffer_store_dwordx4 v[48:51], v25, s[28:31], 0 offen offset:0
    v_cvt_pk_bf16_f32 v40, v100, v101
    v_cvt_pk_bf16_f32 v41, v102, v103
    v_lshlrev_b32 v100, 16, v40
    v_and_b32 v101, 0xffff0000, v40
    v_lshlrev_b32 v102, 16, v41
    v_and_b32 v103, 0xffff0000, v41
    v_pk_add_f32 v[100:101], v[100:101], v[32:33]
    v_pk_add_f32 v[102:103], v[102:103], v[34:35]
    v_cvt_pk_bf16_f32 v40, v100, v101
    v_cvt_pk_bf16_f32 v41, v102, v103
    v_lshlrev_b32 v100, 16, v40
    v_and_b32 v101, 0xffff0000, v40
    v_lshlrev_b32 v102, 16, v41
    v_and_b32 v103, 0xffff0000, v41
    v_pk_mul_f32 v[40:41], v[100:101], v[100:101]
    v_pk_mul_f32 v[42:43], v[102:103], v[102:103]
    v_pk_fma_f32 v[40:41], v[40:41], s[44:45], v[56:57]
    v_pk_fma_f32 v[42:43], v[42:43], s[44:45], v[56:57]
    v_pk_mul_f32 v[40:41], v[40:41], v[100:101]
    v_pk_mul_f32 v[42:43], v[42:43], v[102:103]
    v_exp_f32 v40, v40
    v_exp_f32 v41, v41
    v_exp_f32 v42, v42
    v_exp_f32 v43, v43
    s_nop 0
    v_pk_add_f32 v[40:41], v[40:41], v[58:59]
    v_pk_add_f32 v[42:43], v[42:43], v[58:59]
    v_rcp_f32 v40, v40
    v_rcp_f32 v41, v41
    v_rcp_f32 v42, v42
    v_rcp_f32 v43, v43
    s_nop 0
    v_pk_mul_f32 v[100:101], v[100:101], v[40:41]
    v_pk_mul_f32 v[102:103], v[102:103], v[42:43]
    v_cvt_pk_bf16_f32 v52, v100, v101
    v_cvt_pk_bf16_f32 v53, v102, v103
    v_cvt_pk_bf16_f32 v44, v116, v117
    v_cvt_pk_bf16_f32 v45, v118, v119
    v_lshlrev_b32 v116, 16, v44
    v_and_b32 v117, 0xffff0000, v44
    v_lshlrev_b32 v118, 16, v45
    v_and_b32 v119, 0xffff0000, v45
    v_pk_add_f32 v[116:117], v[116:117], v[36:37]
    v_pk_add_f32 v[118:119], v[118:119], v[38:39]
    v_cvt_pk_bf16_f32 v44, v116, v117
    v_cvt_pk_bf16_f32 v45, v118, v119
    v_lshlrev_b32 v116, 16, v44
    v_and_b32 v117, 0xffff0000, v44
    v_lshlrev_b32 v118, 16, v45
    v_and_b32 v119, 0xffff0000, v45
    v_pk_mul_f32 v[44:45], v[116:117], v[116:117]
    v_pk_mul_f32 v[46:47], v[118:119], v[118:119]
    v_pk_fma_f32 v[44:45], v[44:45], s[44:45], v[56:57]
    v_pk_fma_f32 v[46:47], v[46:47], s[44:45], v[56:57]
    v_pk_mul_f32 v[44:45], v[44:45], v[116:117]
    v_pk_mul_f32 v[46:47], v[46:47], v[118:119]
    v_exp_f32 v44, v44
    v_exp_f32 v45, v45
    v_exp_f32 v46, v46
    v_exp_f32 v47, v47
    s_nop 0
    v_pk_add_f32 v[44:45], v[44:45], v[58:59]
    v_pk_add_f32 v[46:47], v[46:47], v[58:59]
    v_rcp_f32 v44, v44
    v_rcp_f32 v45, v45
    v_rcp_f32 v46, v46
    v_rcp_f32 v47, v47
    s_nop 0
    v_pk_mul_f32 v[116:117], v[116:117], v[44:45]
    v_pk_mul_f32 v[118:119], v[118:119], v[46:47]
    v_cvt_pk_bf16_f32 v54, v116, v117
    v_cvt_pk_bf16_f32 v55, v118, v119
    buffer_store_dwordx4 v[52:55], v25, s[28:31], 0 offen offset:1024
    v_cvt_pk_bf16_f32 v40, v104, v105
    v_cvt_pk_bf16_f32 v41, v106, v107
    v_lshlrev_b32 v104, 16, v40
    v_and_b32 v105, 0xffff0000, v40
    v_lshlrev_b32 v106, 16, v41
    v_and_b32 v107, 0xffff0000, v41
    v_pk_add_f32 v[104:105], v[104:105], v[32:33]
    v_pk_add_f32 v[106:107], v[106:107], v[34:35]
    v_cvt_pk_bf16_f32 v40, v104, v105
    v_cvt_pk_bf16_f32 v41, v106, v107
    v_lshlrev_b32 v104, 16, v40
    v_and_b32 v105, 0xffff0000, v40
    v_lshlrev_b32 v106, 16, v41
    v_and_b32 v107, 0xffff0000, v41
    v_pk_mul_f32 v[40:41], v[104:105], v[104:105]
    v_pk_mul_f32 v[42:43], v[106:107], v[106:107]
    v_pk_fma_f32 v[40:41], v[40:41], s[44:45], v[56:57]
    v_pk_fma_f32 v[42:43], v[42:43], s[44:45], v[56:57]
    v_pk_mul_f32 v[40:41], v[40:41], v[104:105]
    v_pk_mul_f32 v[42:43], v[42:43], v[106:107]
    v_exp_f32 v40, v40
    v_exp_f32 v41, v41
    v_exp_f32 v42, v42
    v_exp_f32 v43, v43
    s_nop 0
    v_pk_add_f32 v[40:41], v[40:41], v[58:59]
    v_pk_add_f32 v[42:43], v[42:43], v[58:59]
    v_rcp_f32 v40, v40
    v_rcp_f32 v41, v41
    v_rcp_f32 v42, v42
    v_rcp_f32 v43, v43
    s_nop 0
    v_pk_mul_f32 v[104:105], v[104:105], v[40:41]
    v_pk_mul_f32 v[106:107], v[106:107], v[42:43]
    v_cvt_pk_bf16_f32 v48, v104, v105
    v_cvt_pk_bf16_f32 v49, v106, v107
    v_cvt_pk_bf16_f32 v44, v120, v121
    v_cvt_pk_bf16_f32 v45, v122, v123
    v_lshlrev_b32 v120, 16, v44
    v_and_b32 v121, 0xffff0000, v44
    v_lshlrev_b32 v122, 16, v45
    v_and_b32 v123, 0xffff0000, v45
    v_pk_add_f32 v[120:121], v[120:121], v[36:37]
    v_pk_add_f32 v[122:123], v[122:123], v[38:39]
    v_cvt_pk_bf16_f32 v44, v120, v121
    v_cvt_pk_bf16_f32 v45, v122, v123
    v_lshlrev_b32 v120, 16, v44
    v_and_b32 v121, 0xffff0000, v44
    v_lshlrev_b32 v122, 16, v45
    v_and_b32 v123, 0xffff0000, v45
    v_pk_mul_f32 v[44:45], v[120:121], v[120:121]
    v_pk_mul_f32 v[46:47], v[122:123], v[122:123]
    v_pk_fma_f32 v[44:45], v[44:45], s[44:45], v[56:57]
    v_pk_fma_f32 v[46:47], v[46:47], s[44:45], v[56:57]
    v_pk_mul_f32 v[44:45], v[44:45], v[120:121]
    v_pk_mul_f32 v[46:47], v[46:47], v[122:123]
    v_exp_f32 v44, v44
    v_exp_f32 v45, v45
    v_exp_f32 v46, v46
    v_exp_f32 v47, v47
    s_nop 0
    v_pk_add_f32 v[44:45], v[44:45], v[58:59]
    v_pk_add_f32 v[46:47], v[46:47], v[58:59]
    v_rcp_f32 v44, v44
    v_rcp_f32 v45, v45
    v_rcp_f32 v46, v46
    v_rcp_f32 v47, v47
    s_nop 0
    v_pk_mul_f32 v[120:121], v[120:121], v[44:45]
    v_pk_mul_f32 v[122:123], v[122:123], v[46:47]
    v_cvt_pk_bf16_f32 v50, v120, v121
    v_cvt_pk_bf16_f32 v51, v122, v123
    buffer_store_dwordx4 v[48:51], v25, s[28:31], 0 offen offset:2048
    v_cvt_pk_bf16_f32 v40, v108, v109
    v_cvt_pk_bf16_f32 v41, v110, v111
    v_lshlrev_b32 v108, 16, v40
    v_and_b32 v109, 0xffff0000, v40
    v_lshlrev_b32 v110, 16, v41
    v_and_b32 v111, 0xffff0000, v41
    v_pk_add_f32 v[108:109], v[108:109], v[32:33]
    v_pk_add_f32 v[110:111], v[110:111], v[34:35]
    v_cvt_pk_bf16_f32 v40, v108, v109
    v_cvt_pk_bf16_f32 v41, v110, v111
    v_lshlrev_b32 v108, 16, v40
    v_and_b32 v109, 0xffff0000, v40
    v_lshlrev_b32 v110, 16, v41
    v_and_b32 v111, 0xffff0000, v41
    v_pk_mul_f32 v[40:41], v[108:109], v[108:109]
    v_pk_mul_f32 v[42:43], v[110:111], v[110:111]
    v_pk_fma_f32 v[40:41], v[40:41], s[44:45], v[56:57]
    v_pk_fma_f32 v[42:43], v[42:43], s[44:45], v[56:57]
    v_pk_mul_f32 v[40:41], v[40:41], v[108:109]
    v_pk_mul_f32 v[42:43], v[42:43], v[110:111]
    v_exp_f32 v40, v40
    v_exp_f32 v41, v41
    v_exp_f32 v42, v42
    v_exp_f32 v43, v43
    s_nop 0
    v_pk_add_f32 v[40:41], v[40:41], v[58:59]
    v_pk_add_f32 v[42:43], v[42:43], v[58:59]
    v_rcp_f32 v40, v40
    v_rcp_f32 v41, v41
    v_rcp_f32 v42, v42
    v_rcp_f32 v43, v43
    s_nop 0
    v_pk_mul_f32 v[108:109], v[108:109], v[40:41]
    v_pk_mul_f32 v[110:111], v[110:111], v[42:43]
    v_cvt_pk_bf16_f32 v52, v108, v109
    v_cvt_pk_bf16_f32 v53, v110, v111
    v_cvt_pk_bf16_f32 v44, v124, v125
    v_cvt_pk_bf16_f32 v45, v126, v127
    v_lshlrev_b32 v124, 16, v44
    v_and_b32 v125, 0xffff0000, v44
    v_lshlrev_b32 v126, 16, v45
    v_and_b32 v127, 0xffff0000, v45
    v_pk_add_f32 v[124:125], v[124:125], v[36:37]
    v_pk_add_f32 v[126:127], v[126:127], v[38:39]
    v_cvt_pk_bf16_f32 v44, v124, v125
    v_cvt_pk_bf16_f32 v45, v126, v127
    v_lshlrev_b32 v124, 16, v44
    v_and_b32 v125, 0xffff0000, v44
    v_lshlrev_b32 v126, 16, v45
    v_and_b32 v127, 0xffff0000, v45
    v_pk_mul_f32 v[44:45], v[124:125], v[124:125]
    v_pk_mul_f32 v[46:47], v[126:127], v[126:127]
    v_pk_fma_f32 v[44:45], v[44:45], s[44:45], v[56:57]
    v_pk_fma_f32 v[46:47], v[46:47], s[44:45], v[56:57]
    v_pk_mul_f32 v[44:45], v[44:45], v[124:125]
    v_pk_mul_f32 v[46:47], v[46:47], v[126:127]
    v_exp_f32 v44, v44
    v_exp_f32 v45, v45
    v_exp_f32 v46, v46
    v_exp_f32 v47, v47
    s_nop 0
    v_pk_add_f32 v[44:45], v[44:45], v[58:59]
    v_pk_add_f32 v[46:47], v[46:47], v[58:59]
    v_rcp_f32 v44, v44
    v_rcp_f32 v45, v45
    v_rcp_f32 v46, v46
    v_rcp_f32 v47, v47
    s_nop 0
    v_pk_mul_f32 v[124:125], v[124:125], v[44:45]
    v_pk_mul_f32 v[126:127], v[126:127], v[46:47]
    v_cvt_pk_bf16_f32 v54, v124, v125
    v_cvt_pk_bf16_f32 v55, v126, v127
    buffer_store_dwordx4 v[52:55], v25, s[28:31], 0 offen offset:3072
    s_waitcnt vmcnt(0)
    s_endpgm
g1_loader:
    s_sub_u32 s16, s16, 4
    v_and_b32 v4, 15, v1
    v_lshlrev_b32 v5, 1, v3
    v_xor_b32 v5, v5, v4
    v_xor_b32 v6, 8, v5
    s_lshl_b32 s17, s16, 4
    v_add_u32 v3, s17, v3
    s_lshl_b32 s18, s14, 8
    s_lshl_b32 s19, s15, 8
    s_movk_i32 s36, 7168
    v_add_u32 v7, 0, v3
    v_mul_lo_u32 v8, v7, s36
    v_lshl_add_u32 v8, v5, 4, v8
    v_add_u32 v8, s18, v8
    v_lshlrev_b32 v12, 11, v7
    v_lshl_add_u32 v12, v5, 4, v12
    v_add_u32 v12, s19, v12
    v_add_u32 v7, 4, v3
    v_mul_lo_u32 v9, v7, s36
    v_lshl_add_u32 v9, v5, 4, v9
    v_add_u32 v9, s18, v9
    v_lshlrev_b32 v13, 11, v7
    v_lshl_add_u32 v13, v5, 4, v13
    v_add_u32 v13, s19, v13
    v_subrev_u32 v9, 1024, v9
    v_subrev_u32 v13, 1024, v13
    v_add_u32 v7, 8, v3
    v_mul_lo_u32 v10, v7, s36
    v_lshl_add_u32 v10, v6, 4, v10
    v_add_u32 v10, s18, v10
    v_lshlrev_b32 v14, 11, v7
    v_lshl_add_u32 v14, v6, 4, v14
    v_add_u32 v14, s19, v14
    v_subrev_u32 v10, 2048, v10
    v_subrev_u32 v14, 2048, v14
    v_add_u32 v7, 12, v3
    v_mul_lo_u32 v11, v7, s36
    v_lshl_add_u32 v11, v6, 4, v11
    v_add_u32 v11, s18, v11
    v_lshlrev_b32 v15, 11, v7
    v_lshl_add_u32 v15, v6, 4, v15
    v_add_u32 v15, s19, v15
    v_subrev_u32 v11, 3072, v11
    v_subrev_u32 v15, 3072, v15
    s_lshl_b32 s37, s16, 12
    s_add_u32 m0, s37, 0
    s_mov_b32 s38, 0
    s_mov_b32 s39, 0
    buffer_load_dwordx4 v8, s[20:23], s38 offen offset:0 lds
    buffer_load_dwordx4 v9, s[20:23], s38 offen offset:1024 lds
    buffer_load_dwordx4 v10, s[20:23], s38 offen offset:2048 lds
    buffer_load_dwordx4 v11, s[20:23], s38 offen offset:3072 lds
    s_add_u32 m0, s37, 16384
    s_nop 0
    buffer_load_dwordx4 v12, s[24:27], s39 offen offset:0 lds
    buffer_load_dwordx4 v13, s[24:27], s39 offen offset:1024 lds
    buffer_load_dwordx4 v14, s[24:27], s39 offen offset:2048 lds
    buffer_load_dwordx4 v15, s[24:27], s39 offen offset:3072 lds
    s_add_u32 m0, s37, 32768
    s_mov_b32 s38, 458752
    s_mov_b32 s39, 131072
    buffer_load_dwordx4 v8, s[20:23], s38 offen offset:0 lds
    buffer_load_dwordx4 v9, s[20:23], s38 offen offset:1024 lds
    buffer_load_dwordx4 v10, s[20:23], s38 offen offset:2048 lds
    buffer_load_dwordx4 v11, s[20:23], s38 offen offset:3072 lds
    s_add_u32 m0, s37, 49152
    s_nop 0
    buffer_load_dwordx4 v12, s[24:27], s39 offen offset:0 lds
    buffer_load_dwordx4 v13, s[24:27], s39 offen offset:1024 lds
    buffer_load_dwordx4 v14, s[24:27], s39 offen offset:2048 lds
    buffer_load_dwordx4 v15, s[24:27], s39 offen offset:3072 lds
    s_add_u32 m0, s37, 65536
    s_mov_b32 s38, 917504
    s_mov_b32 s39, 262144
    buffer_load_dwordx4 v8, s[20:23], s38 offen offset:0 lds
    buffer_load_dwordx4 v9, s[20:23], s38 offen offset:1024 lds
    buffer_load_dwordx4 v10, s[20:23], s38 offen offset:2048 lds
    buffer_load_dwordx4 v11, s[20:23], s38 offen offset:3072 lds
    s_add_u32 m0, s37, 81920
    s_nop 0
    buffer_load_dwordx4 v12, s[24:27], s39 offen offset:0 lds
    buffer_load_dwordx4 v13, s[24:27], s39 offen offset:1024 lds
    buffer_load_dwordx4 v14, s[24:27], s39 offen offset:2048 lds
    buffer_load_dwordx4 v15, s[24:27], s39 offen offset:3072 lds
    s_add_u32 s16, s16, 4
    s_mov_b32 s46, s37
    v_lshrrev_b32 v3, 4, v1
    s_add_u32 s28, s8, 16777216
    s_addc_u32 s29, s9, 0
    s_mov_b32 s30, 7340032
    s_mov_b32 s31, 0x00020000
    s_mov_b32 s32, s6
    s_mov_b32 s33, s7
    s_mov_b32 s34, 7168
    s_mov_b32 s35, 0x00020000
    s_and_b32 s17, s16, 1
    s_bfe_u32 s18, s16, 0x10001
    s_lshr_b32 s19, s16, 2
    s_lshl_b32 s37, s14, 7
    s_lshl_b32 s38, s17, 6
    s_add_u32 s37, s37, s38
    s_lshl_b32 s38, s19, 5
    s_add_u32 s37, s37, s38
    v_lshl_add_u32 v24, v3, 2, s37
    v_lshlrev_b32 v24, 1, v24
    buffer_load_dwordx2 v[28:29], v24, s[32:35], 0 offen offset:0
    buffer_load_dwordx2 v[30:31], v24, s[32:35], 0 offen offset:32
    s_mul_i32 s37, s15, 112
    s_lshl_b32 s38, s14, 2
    s_add_u32 s37, s37, s38
    s_lshl_b32 s38, s17, 1
    s_add_u32 s37, s37, s38
    s_add_u32 s37, s37, s19
    s_lshl_b32 s37, s37, 3
    s_lshl_b32 s38, s18, 2
    s_add_u32 s37, s37, s38
    s_lshl_b32 s37, s37, 10
    v_lshl_add_u32 v25, v1, 4, s37
    s_and_b32 s37, s16, 3
    s_lshl_b32 s37, s37, 13
    v_lshl_add_u32 v26, v1, 4, s37
    s_mov_b32 s42, 0xc0135761
    s_mov_b32 s43, 0xc0135761
    s_mov_b32 s44, 0xbdd2d3e8
    s_mov_b32 s45, 0xbdd2d3e8
    s_mov_b32 s37, s46
    s_sub_u32 s16, s16, 4
    s_waitcnt vmcnt(18)
    s_barrier
    s_waitcnt vmcnt(10)
    s_barrier
    s_add_u32 m0, s37, 0
    s_mov_b32 s38, 1376256
    s_mov_b32 s39, 393216
    buffer_load_dwordx4 v8, s[20:23], s38 offen offset:0 lds
    buffer_load_dwordx4 v9, s[20:23], s38 offen offset:1024 lds
    buffer_load_dwordx4 v10, s[20:23], s38 offen offset:2048 lds
    buffer_load_dwordx4 v11, s[20:23], s38 offen offset:3072 lds
    s_add_u32 m0, s37, 16384
    s_nop 0
    buffer_load_dwordx4 v12, s[24:27], s39 offen offset:0 lds
    buffer_load_dwordx4 v13, s[24:27], s39 offen offset:1024 lds
    buffer_load_dwordx4 v14, s[24:27], s39 offen offset:2048 lds
    buffer_load_dwordx4 v15, s[24:27], s39 offen offset:3072 lds
    s_waitcnt vmcnt(10)
    s_barrier
    s_add_u32 m0, s37, 32768
    s_mov_b32 s38, 1835008
    s_mov_b32 s39, 524288
    buffer_load_dwordx4 v8, s[20:23], s38 offen offset:0 lds
    buffer_load_dwordx4 v9, s[20:23], s38 offen offset:1024 lds
    buffer_load_dwordx4 v10, s[20:23], s38 offen offset:2048 lds
    buffer_load_dwordx4 v11, s[20:23], s38 offen offset:3072 lds
    s_add_u32 m0, s37, 49152
    s_nop 0
    buffer_load_dwordx4 v12, s[24:27], s39 offen offset:0 lds
    buffer_load_dwordx4 v13, s[24:27], s39 offen offset:1024 lds
    buffer_load_dwordx4 v14, s[24:27], s39 offen offset:2048 lds
    buffer_load_dwordx4 v15, s[24:27], s39 offen offset:3072 lds
    s_waitcnt vmcnt(8)
    s_barrier
    s_add_u32 m0, s37, 65536
    s_mov_b32 s38, 2293760
    s_mov_b32 s39, 655360
    buffer_load_dwordx4 v8, s[20:23], s38 offen offset:0 lds
    buffer_load_dwordx4 v9, s[20:23], s38 offen offset:1024 lds
    buffer_load_dwordx4 v10, s[20:23], s38 offen offset:2048 lds
    buffer_load_dwordx4 v11, s[20:23], s38 offen offset:3072 lds
    s_add_u32 m0, s37, 81920
    s_nop 0
    buffer_load_dwordx4 v12, s[24:27], s39 offen offset:0 lds
    buffer_load_dwordx4 v13, s[24:27], s39 offen offset:1024 lds
    buffer_load_dwordx4 v14, s[24:27], s39 offen offset:2048 lds
    buffer_load_dwordx4 v15, s[24:27], s39 offen offset:3072 lds
    s_waitcnt vmcnt(8)
    s_barrier
    s_add_u32 m0, s37, 0
    s_mov_b32 s38, 2752512
    s_mov_b32 s39, 786432
    buffer_load_dwordx4 v8, s[20:23], s38 offen offset:0 lds
    buffer_load_dwordx4 v9, s[20:23], s38 offen offset:1024 lds
    buffer_load_dwordx4 v10, s[20:23], s38 offen offset:2048 lds
    buffer_load_dwordx4 v11, s[20:23], s38 offen offset:3072 lds
    s_add_u32 m0, s37, 16384
    s_nop 0
    buffer_load_dwordx4 v12, s[24:27], s39 offen offset:0 lds
    buffer_load_dwordx4 v13, s[24:27], s39 offen offset:1024 lds
    buffer_load_dwordx4 v14, s[24:27], s39 offen offset:2048 lds
    buffer_load_dwordx4 v15, s[24:27], s39 offen offset:3072 lds
    s_waitcnt vmcnt(8)
    s_barrier
    s_add_u32 m0, s37, 32768
    s_mov_b32 s38, 3211264
    s_mov_b32 s39, 917504
    buffer_load_dwordx4 v8, s[20:23], s38 offen offset:0 lds
    buffer_load_dwordx4 v9, s[20:23], s38 offen offset:1024 lds
    buffer_load_dwordx4 v10, s[20:23], s38 offen offset:2048 lds
    buffer_load_dwordx4 v11, s[20:23], s38 offen offset:3072 lds
    s_add_u32 m0, s37, 49152
    s_nop 0
    buffer_load_dwordx4 v12, s[24:27], s39 offen offset:0 lds
    buffer_load_dwordx4 v13, s[24:27], s39 offen offset:1024 lds
    buffer_load_dwordx4 v14, s[24:27], s39 offen offset:2048 lds
    buffer_load_dwordx4 v15, s[24:27], s39 offen offset:3072 lds
    s_waitcnt vmcnt(8)
    s_barrier
    s_add_u32 m0, s37, 65536
    s_mov_b32 s38, 3670016
    s_mov_b32 s39, 1048576
    buffer_load_dwordx4 v8, s[20:23], s38 offen offset:0 lds
    buffer_load_dwordx4 v9, s[20:23], s38 offen offset:1024 lds
    buffer_load_dwordx4 v10, s[20:23], s38 offen offset:2048 lds
    buffer_load_dwordx4 v11, s[20:23], s38 offen offset:3072 lds
    s_add_u32 m0, s37, 81920
    s_nop 0
    buffer_load_dwordx4 v12, s[24:27], s39 offen offset:0 lds
    buffer_load_dwordx4 v13, s[24:27], s39 offen offset:1024 lds
    buffer_load_dwordx4 v14, s[24:27], s39 offen offset:2048 lds
    buffer_load_dwordx4 v15, s[24:27], s39 offen offset:3072 lds
    s_waitcnt vmcnt(8)
    s_barrier
    s_add_u32 m0, s37, 0
    s_mov_b32 s38, 4128768
    s_mov_b32 s39, 1179648
    buffer_load_dwordx4 v8, s[20:23], s38 offen offset:0 lds
    buffer_load_dwordx4 v9, s[20:23], s38 offen offset:1024 lds
    buffer_load_dwordx4 v10, s[20:23], s38 offen offset:2048 lds
    buffer_load_dwordx4 v11, s[20:23], s38 offen offset:3072 lds
    s_add_u32 m0, s37, 16384
    s_nop 0
    buffer_load_dwordx4 v12, s[24:27], s39 offen offset:0 lds
    buffer_load_dwordx4 v13, s[24:27], s39 offen offset:1024 lds
    buffer_load_dwordx4 v14, s[24:27], s39 offen offset:2048 lds
    buffer_load_dwordx4 v15, s[24:27], s39 offen offset:3072 lds
    s_waitcnt vmcnt(8)
    s_barrier
    s_add_u32 m0, s37, 32768
    s_mov_b32 s38, 4587520
    s_mov_b32 s39, 1310720
    buffer_load_dwordx4 v8, s[20:23], s38 offen offset:0 lds
    buffer_load_dwordx4 v9, s[20:23], s38 offen offset:1024 lds
    buffer_load_dwordx4 v10, s[20:23], s38 offen offset:2048 lds
    buffer_load_dwordx4 v11, s[20:23], s38 offen offset:3072 lds
    s_add_u32 m0, s37, 49152
    s_nop 0
    buffer_load_dwordx4 v12, s[24:27], s39 offen offset:0 lds
    buffer_load_dwordx4 v13, s[24:27], s39 offen offset:1024 lds
    buffer_load_dwordx4 v14, s[24:27], s39 offen offset:2048 lds
    buffer_load_dwordx4 v15, s[24:27], s39 offen offset:3072 lds
    s_waitcnt vmcnt(8)
    s_barrier
    s_add_u32 m0, s37, 65536
    s_mov_b32 s38, 5046272
    s_mov_b32 s39, 1441792
    buffer_load_dwordx4 v8, s[20:23], s38 offen offset:0 lds
    buffer_load_dwordx4 v9, s[20:23], s38 offen offset:1024 lds
    buffer_load_dwordx4 v10, s[20:23], s38 offen offset:2048 lds
    buffer_load_dwordx4 v11, s[20:23], s38 offen offset:3072 lds
    s_add_u32 m0, s37, 81920
    s_nop 0
    buffer_load_dwordx4 v12, s[24:27], s39 offen offset:0 lds
    buffer_load_dwordx4 v13, s[24:27], s39 offen offset:1024 lds
    buffer_load_dwordx4 v14, s[24:27], s39 offen offset:2048 lds
    buffer_load_dwordx4 v15, s[24:27], s39 offen offset:3072 lds
    s_waitcnt vmcnt(8)
    s_barrier
    s_add_u32 m0, s37, 0
    s_mov_b32 s38, 5505024
    s_mov_b32 s39, 1572864
    buffer_load_dwordx4 v8, s[20:23], s38 offen offset:0 lds
    buffer_load_dwordx4 v9, s[20:23], s38 offen offset:1024 lds
    buffer_load_dwordx4 v10, s[20:23], s38 offen offset:2048 lds
    buffer_load_dwordx4 v11, s[20:23], s38 offen offset:3072 lds
    s_add_u32 m0, s37, 16384
    s_nop 0
    buffer_load_dwordx4 v12, s[24:27], s39 offen offset:0 lds
    buffer_load_dwordx4 v13, s[24:27], s39 offen offset:1024 lds
    buffer_load_dwordx4 v14, s[24:27], s39 offen offset:2048 lds
    buffer_load_dwordx4 v15, s[24:27], s39 offen offset:3072 lds
    s_waitcnt vmcnt(8)
    s_barrier
    s_add_u32 m0, s37, 32768
    s_mov_b32 s38, 5963776
    s_mov_b32 s39, 1703936
    buffer_load_dwordx4 v8, s[20:23], s38 offen offset:0 lds
    buffer_load_dwordx4 v9, s[20:23], s38 offen offset:1024 lds
    buffer_load_dwordx4 v10, s[20:23], s38 offen offset:2048 lds
    buffer_load_dwordx4 v11, s[20:23], s38 offen offset:3072 lds
    s_add_u32 m0, s37, 49152
    s_nop 0
    buffer_load_dwordx4 v12, s[24:27], s39 offen offset:0 lds
    buffer_load_dwordx4 v13, s[24:27], s39 offen offset:1024 lds
    buffer_load_dwordx4 v14, s[24:27], s39 offen offset:2048 lds
    buffer_load_dwordx4 v15, s[24:27], s39 offen offset:3072 lds
    s_waitcnt vmcnt(8)
    s_barrier
    s_add_u32 m0, s37, 65536
    s_mov_b32 s38, 6422528
    s_mov_b32 s39, 1835008
    buffer_load_dwordx4 v8, s[20:23], s38 offen offset:0 lds
    buffer_load_dwordx4 v9, s[20:23], s38 offen offset:1024 lds
    buffer_load_dwordx4 v10, s[20:23], s38 offen offset:2048 lds
    buffer_load_dwordx4 v11, s[20:23], s38 offen offset:3072 lds
    s_add_u32 m0, s37, 81920
    s_nop 0
    buffer_load_dwordx4 v12, s[24:27], s39 offen offset:0 lds
    buffer_load_dwordx4 v13, s[24:27], s39 offen offset:1024 lds
    buffer_load_dwordx4 v14, s[24:27], s39 offen offset:2048 lds
    buffer_load_dwordx4 v15, s[24:27], s39 offen offset:3072 lds
    s_waitcnt vmcnt(8)
    s_barrier
    s_add_u32 m0, s37, 0
    s_mov_b32 s38, 6881280
    s_mov_b32 s39, 1966080
    buffer_load_dwordx4 v8, s[20:23], s38 offen offset:0 lds
    buffer_load_dwordx4 v9, s[20:23], s38 offen offset:1024 lds
    buffer_load_dwordx4 v10, s[20:23], s38 offen offset:2048 lds
    buffer_load_dwordx4 v11, s[20:23], s38 offen offset:3072 lds
    s_add_u32 m0, s37, 16384
    s_nop 0
    buffer_load_dwordx4 v12, s[24:27], s39 offen offset:0 lds
    buffer_load_dwordx4 v13, s[24:27], s39 offen offset:1024 lds
    buffer_load_dwordx4 v14, s[24:27], s39 offen offset:2048 lds
    buffer_load_dwordx4 v15, s[24:27], s39 offen offset:3072 lds
    s_waitcnt vmcnt(8)
    s_barrier
    s_add_u32 m0, s37, 32768
    s_mov_b32 s38, 7340032
    s_mov_b32 s39, 2097152
    buffer_load_dwordx4 v8, s[20:23], s38 offen offset:0 lds
    buffer_load_dwordx4 v9, s[20:23], s38 offen offset:1024 lds
    buffer_load_dwordx4 v10, s[20:23], s38 offen offset:2048 lds
    buffer_load_dwordx4 v11, s[20:23], s38 offen offset:3072 lds
    s_add_u32 m0, s37, 49152
    s_nop 0
    buffer_load_dwordx4 v12, s[24:27], s39 offen offset:0 lds
    buffer_load_dwordx4 v13, s[24:27], s39 offen offset:1024 lds
    buffer_load_dwordx4 v14, s[24:27], s39 offen offset:2048 lds
    buffer_load_dwordx4 v15, s[24:27], s39 offen offset:3072 lds
    s_waitcnt vmcnt(8)
    s_barrier
    s_add_u32 m0, s37, 65536
    s_mov_b32 s38, 7798784
    s_mov_b32 s39, 2228224
    buffer_load_dwordx4 v8, s[20:23], s38 offen offset:0 lds
    buffer_load_dwordx4 v9, s[20:23], s38 offen offset:1024 lds
    buffer_load_dwordx4 v10, s[20:23], s38 offen offset:2048 lds
    buffer_load_dwordx4 v11, s[20:23], s38 offen offset:3072 lds
    s_add_u32 m0, s37, 81920
    s_nop 0
    buffer_load_dwordx4 v12, s[24:27], s39 offen offset:0 lds
    buffer_load_dwordx4 v13, s[24:27], s39 offen offset:1024 lds
    buffer_load_dwordx4 v14, s[24:27], s39 offen offset:2048 lds
    buffer_load_dwordx4 v15, s[24:27], s39 offen offset:3072 lds
    s_waitcnt vmcnt(8)
    s_barrier
    s_add_u32 m0, s37, 0
    s_mov_b32 s38, 8257536
    s_mov_b32 s39, 2359296
    buffer_load_dwordx4 v8, s[20:23], s38 offen offset:0 lds
    buffer_load_dwordx4 v9, s[20:23], s38 offen offset:1024 lds
    buffer_load_dwordx4 v10, s[20:23], s38 offen offset:2048 lds
    buffer_load_dwordx4 v11, s[20:23], s38 offen offset:3072 lds
    s_add_u32 m0, s37, 16384
    s_nop 0
    buffer_load_dwordx4 v12, s[24:27], s39 offen offset:0 lds
    buffer_load_dwordx4 v13, s[24:27], s39 offen offset:1024 lds
    buffer_load_dwordx4 v14, s[24:27], s39 offen offset:2048 lds
    buffer_load_dwordx4 v15, s[24:27], s39 offen offset:3072 lds
    s_waitcnt vmcnt(8)
    s_barrier
    s_add_u32 m0, s37, 32768
    s_mov_b32 s38, 8716288
    s_mov_b32 s39, 2490368
    buffer_load_dwordx4 v8, s[20:23], s38 offen offset:0 lds
    buffer_load_dwordx4 v9, s[20:23], s38 offen offset:1024 lds
    buffer_load_dwordx4 v10, s[20:23], s38 offen offset:2048 lds
    buffer_load_dwordx4 v11, s[20:23], s38 offen offset:3072 lds
    s_add_u32 m0, s37, 49152
    s_nop 0
    buffer_load_dwordx4 v12, s[24:27], s39 offen offset:0 lds
    buffer_load_dwordx4 v13, s[24:27], s39 offen offset:1024 lds
    buffer_load_dwordx4 v14, s[24:27], s39 offen offset:2048 lds
    buffer_load_dwordx4 v15, s[24:27], s39 offen offset:3072 lds
    s_waitcnt vmcnt(8)
    s_barrier
    s_add_u32 m0, s37, 65536
    s_mov_b32 s38, 9175040
    s_mov_b32 s39, 2621440
    buffer_load_dwordx4 v8, s[20:23], s38 offen offset:0 lds
    buffer_load_dwordx4 v9, s[20:23], s38 offen offset:1024 lds
    buffer_load_dwordx4 v10, s[20:23], s38 offen offset:2048 lds
    buffer_load_dwordx4 v11, s[20:23], s38 offen offset:3072 lds
    s_add_u32 m0, s37, 81920
    s_nop 0
    buffer_load_dwordx4 v12, s[24:27], s39 offen offset:0 lds
    buffer_load_dwordx4 v13, s[24:27], s39 offen offset:1024 lds
    buffer_load_dwordx4 v14, s[24:27], s39 offen offset:2048 lds
    buffer_load_dwordx4 v15, s[24:27], s39 offen offset:3072 lds
    s_waitcnt vmcnt(8)
    s_barrier
    s_add_u32 m0, s37, 0
    s_mov_b32 s38, 9633792
    s_mov_b32 s39, 2752512
    buffer_load_dwordx4 v8, s[20:23], s38 offen offset:0 lds
    buffer_load_dwordx4 v9, s[20:23], s38 offen offset:1024 lds
    buffer_load_dwordx4 v10, s[20:23], s38 offen offset:2048 lds
    buffer_load_dwordx4 v11, s[20:23], s38 offen offset:3072 lds
    s_add_u32 m0, s37, 16384
    s_nop 0
    buffer_load_dwordx4 v12, s[24:27], s39 offen offset:0 lds
    buffer_load_dwordx4 v13, s[24:27], s39 offen offset:1024 lds
    buffer_load_dwordx4 v14, s[24:27], s39 offen offset:2048 lds
    buffer_load_dwordx4 v15, s[24:27], s39 offen offset:3072 lds
    s_waitcnt vmcnt(8)
    s_barrier
    s_add_u32 m0, s37, 32768
    s_mov_b32 s38, 10092544
    s_mov_b32 s39, 2883584
    buffer_load_dwordx4 v8, s[20:23], s38 offen offset:0 lds
    buffer_load_dwordx4 v9, s[20:23], s38 offen offset:1024 lds
    buffer_load_dwordx4 v10, s[20:23], s38 offen offset:2048 lds
    buffer_load_dwordx4 v11, s[20:23], s38 offen offset:3072 lds
    s_add_u32 m0, s37, 49152
    s_nop 0
    buffer_load_dwordx4 v12, s[24:27], s39 offen offset:0 lds
    buffer_load_dwordx4 v13, s[24:27], s39 offen offset:1024 lds
    buffer_load_dwordx4 v14, s[24:27], s39 offen offset:2048 lds
    buffer_load_dwordx4 v15, s[24:27], s39 offen offset:3072 lds
    s_waitcnt vmcnt(8)
    s_barrier
    s_add_u32 m0, s37, 65536
    s_mov_b32 s38, 10551296
    s_mov_b32 s39, 3014656
    buffer_load_dwordx4 v8, s[20:23], s38 offen offset:0 lds
    buffer_load_dwordx4 v9, s[20:23], s38 offen offset:1024 lds
    buffer_load_dwordx4 v10, s[20:23], s38 offen offset:2048 lds
    buffer_load_dwordx4 v11, s[20:23], s38 offen offset:3072 lds
    s_add_u32 m0, s37, 81920
    s_nop 0
    buffer_load_dwordx4 v12, s[24:27], s39 offen offset:0 lds
    buffer_load_dwordx4 v13, s[24:27], s39 offen offset:1024 lds
    buffer_load_dwordx4 v14, s[24:27], s39 offen offset:2048 lds
    buffer_load_dwordx4 v15, s[24:27], s39 offen offset:3072 lds
    s_waitcnt vmcnt(8)
    s_barrier
    s_add_u32 m0, s37, 0
    s_mov_b32 s38, 11010048
    s_mov_b32 s39, 3145728
    buffer_load_dwordx4 v8, s[20:23], s38 offen offset:0 lds
    buffer_load_dwordx4 v9, s[20:23], s38 offen offset:1024 lds
    buffer_load_dwordx4 v10, s[20:23], s38 offen offset:2048 lds
    buffer_load_dwordx4 v11, s[20:23], s38 offen offset:3072 lds
    s_add_u32 m0, s37, 16384
    s_nop 0
    buffer_load_dwordx4 v12, s[24:27], s39 offen offset:0 lds
    buffer_load_dwordx4 v13, s[24:27], s39 offen offset:1024 lds
    buffer_load_dwordx4 v14, s[24:27], s39 offen offset:2048 lds
    buffer_load_dwordx4 v15, s[24:27], s39 offen offset:3072 lds
    s_waitcnt vmcnt(8)
    s_barrier
    s_add_u32 m0, s37, 32768
    s_mov_b32 s38, 11468800
    s_mov_b32 s39, 3276800
    buffer_load_dwordx4 v8, s[20:23], s38 offen offset:0 lds
    buffer_load_dwordx4 v9, s[20:23], s38 offen offset:1024 lds
    buffer_load_dwordx4 v10, s[20:23], s38 offen offset:2048 lds
    buffer_load_dwordx4 v11, s[20:23], s38 offen offset:3072 lds
    s_add_u32 m0, s37, 49152
    s_nop 0
    buffer_load_dwordx4 v12, s[24:27], s39 offen offset:0 lds
    buffer_load_dwordx4 v13, s[24:27], s39 offen offset:1024 lds
    buffer_load_dwordx4 v14, s[24:27], s39 offen offset:2048 lds
    buffer_load_dwordx4 v15, s[24:27], s39 offen offset:3072 lds
    s_waitcnt vmcnt(8)
    s_barrier
    s_add_u32 m0, s37, 65536
    s_mov_b32 s38, 11927552
    s_mov_b32 s39, 3407872
    buffer_load_dwordx4 v8, s[20:23], s38 offen offset:0 lds
    buffer_load_dwordx4 v9, s[20:23], s38 offen offset:1024 lds
    buffer_load_dwordx4 v10, s[20:23], s38 offen offset:2048 lds
    buffer_load_dwordx4 v11, s[20:23], s38 offen offset:3072 lds
    s_add_u32 m0, s37, 81920
    s_nop 0
    buffer_load_dwordx4 v12, s[24:27], s39 offen offset:0 lds
    buffer_load_dwordx4 v13, s[24:27], s39 offen offset:1024 lds
    buffer_load_dwordx4 v14, s[24:27], s39 offen offset:2048 lds
    buffer_load_dwordx4 v15, s[24:27], s39 offen offset:3072 lds
    s_waitcnt vmcnt(8)
    s_barrier
    s_add_u32 m0, s37, 0
    s_mov_b32 s38, 12386304
    s_mov_b32 s39, 3538944
    buffer_load_dwordx4 v8, s[20:23], s38 offen offset:0 lds
    buffer_load_dwordx4 v9, s[20:23], s38 offen offset:1024 lds
    buffer_load_dwordx4 v10, s[20:23], s38 offen offset:2048 lds
    buffer_load_dwordx4 v11, s[20:23], s38 offen offset:3072 lds
    s_add_u32 m0, s37, 16384
    s_nop 0
    buffer_load_dwordx4 v12, s[24:27], s39 offen offset:0 lds
    buffer_load_dwordx4 v13, s[24:27], s39 offen offset:1024 lds
    buffer_load_dwordx4 v14, s[24:27], s39 offen offset:2048 lds
    buffer_load_dwordx4 v15, s[24:27], s39 offen offset:3072 lds
    s_waitcnt vmcnt(8)
    s_barrier
    s_add_u32 m0, s37, 32768
    s_mov_b32 s38, 12845056
    s_mov_b32 s39, 3670016
    buffer_load_dwordx4 v8, s[20:23], s38 offen offset:0 lds
    buffer_load_dwordx4 v9, s[20:23], s38 offen offset:1024 lds
    buffer_load_dwordx4 v10, s[20:23], s38 offen offset:2048 lds
    buffer_load_dwordx4 v11, s[20:23], s38 offen offset:3072 lds
    s_add_u32 m0, s37, 49152
    s_nop 0
    buffer_load_dwordx4 v12, s[24:27], s39 offen offset:0 lds
    buffer_load_dwordx4 v13, s[24:27], s39 offen offset:1024 lds
    buffer_load_dwordx4 v14, s[24:27], s39 offen offset:2048 lds
    buffer_load_dwordx4 v15, s[24:27], s39 offen offset:3072 lds
    s_waitcnt vmcnt(8)
    s_barrier
    s_add_u32 m0, s37, 65536
    s_mov_b32 s38, 13303808
    s_mov_b32 s39, 3801088
    buffer_load_dwordx4 v8, s[20:23], s38 offen offset:0 lds
    buffer_load_dwordx4 v9, s[20:23], s38 offen offset:1024 lds
    buffer_load_dwordx4 v10, s[20:23], s38 offen offset:2048 lds
    buffer_load_dwordx4 v11, s[20:23], s38 offen offset:3072 lds
    s_add_u32 m0, s37, 81920
    s_nop 0
    buffer_load_dwordx4 v12, s[24:27], s39 offen offset:0 lds
    buffer_load_dwordx4 v13, s[24:27], s39 offen offset:1024 lds
    buffer_load_dwordx4 v14, s[24:27], s39 offen offset:2048 lds
    buffer_load_dwordx4 v15, s[24:27], s39 offen offset:3072 lds
    s_waitcnt vmcnt(8)
    s_barrier
    s_add_u32 m0, s37, 0
    s_mov_b32 s38, 13762560
    s_mov_b32 s39, 3932160
    buffer_load_dwordx4 v8, s[20:23], s38 offen offset:0 lds
    buffer_load_dwordx4 v9, s[20:23], s38 offen offset:1024 lds
    buffer_load_dwordx4 v10, s[20:23], s38 offen offset:2048 lds
    buffer_load_dwordx4 v11, s[20:23], s38 offen offset:3072 lds
    s_add_u32 m0, s37, 16384
    s_nop 0
    buffer_load_dwordx4 v12, s[24:27], s39 offen offset:0 lds
    buffer_load_dwordx4 v13, s[24:27], s39 offen offset:1024 lds
    buffer_load_dwordx4 v14, s[24:27], s39 offen offset:2048 lds
    buffer_load_dwordx4 v15, s[24:27], s39 offen offset:3072 lds
    s_waitcnt vmcnt(8)
    s_barrier
    s_add_u32 m0, s37, 32768
    s_mov_b32 s38, 14221312
    s_mov_b32 s39, 4063232
    buffer_load_dwordx4 v8, s[20:23], s38 offen offset:0 lds
    buffer_load_dwordx4 v9, s[20:23], s38 offen offset:1024 lds
    buffer_load_dwordx4 v10, s[20:23], s38 offen offset:2048 lds
    buffer_load_dwordx4 v11, s[20:23], s38 offen offset:3072 lds
    s_add_u32 m0, s37, 49152
    s_nop 0
    buffer_load_dwordx4 v12, s[24:27], s39 offen offset:0 lds
    buffer_load_dwordx4 v13, s[24:27], s39 offen offset:1024 lds
    buffer_load_dwordx4 v14, s[24:27], s39 offen offset:2048 lds
    buffer_load_dwordx4 v15, s[24:27], s39 offen offset:3072 lds
    s_waitcnt vmcnt(8)
    s_barrier
    s_waitcnt vmcnt(0)
    s_barrier
    s_barrier
    s_barrier
    ds_read_b128 v[64:67], v26 offset:0
    ds_read_b128 v[68:71], v26 offset:1024
    ds_read_b128 v[72:75], v26 offset:2048
    ds_read_b128 v[76:79], v26 offset:3072
    ds_read_b128 v[80:83], v26 offset:4096
    ds_read_b128 v[84:87], v26 offset:5120
    ds_read_b128 v[88:91], v26 offset:6144
    ds_read_b128 v[92:95], v26 offset:7168
    s_waitcnt lgkmcnt(0)
    v_mov_b32 v56, s42
    v_mov_b32 v57, s42
    v_mov_b32 v58, 1.0
    v_mov_b32 v59, 1.0
    v_lshlrev_b32 v32, 16, v28
    v_and_b32 v33, 0xffff0000, v28
    v_lshlrev_b32 v34, 16, v29
    v_and_b32 v35, 0xffff0000, v29
    v_lshlrev_b32 v36, 16, v30
    v_and_b32 v37, 0xffff0000, v30
    v_lshlrev_b32 v38, 16, v31
    v_and_b32 v39, 0xffff0000, v31
    v_cvt_pk_bf16_f32 v40, v64, v65
    v_cvt_pk_bf16_f32 v41, v66, v67
    v_lshlrev_b32 v64, 16, v40
    v_and_b32 v65, 0xffff0000, v40
    v_lshlrev_b32 v66, 16, v41
    v_and_b32 v67, 0xffff0000, v41
    v_pk_add_f32 v[64:65], v[64:65], v[32:33]
    v_pk_add_f32 v[66:67], v[66:67], v[34:35]
    v_cvt_pk_bf16_f32 v40, v64, v65
    v_cvt_pk_bf16_f32 v41, v66, v67
    v_lshlrev_b32 v64, 16, v40
    v_and_b32 v65, 0xffff0000, v40
    v_lshlrev_b32 v66, 16, v41
    v_and_b32 v67, 0xffff0000, v41
    v_pk_mul_f32 v[40:41], v[64:65], v[64:65]
    v_pk_mul_f32 v[42:43], v[66:67], v[66:67]
    v_pk_fma_f32 v[40:41], v[40:41], s[44:45], v[56:57]
    v_pk_fma_f32 v[42:43], v[42:43], s[44:45], v[56:57]
    v_pk_mul_f32 v[40:41], v[40:41], v[64:65]
    v_pk_mul_f32 v[42:43], v[42:43], v[66:67]
    v_exp_f32 v40, v40
    v_exp_f32 v41, v41
    v_exp_f32 v42, v42
    v_exp_f32 v43, v43
    s_nop 0
    v_pk_add_f32 v[40:41], v[40:41], v[58:59]
    v_pk_add_f32 v[42:43], v[42:43], v[58:59]
    v_rcp_f32 v40, v40
    v_rcp_f32 v41, v41
    v_rcp_f32 v42, v42
    v_rcp_f32 v43, v43
    s_nop 0
    v_pk_mul_f32 v[64:65], v[64:65], v[40:41]
    v_pk_mul_f32 v[66:67], v[66:67], v[42:43]
    v_cvt_pk_bf16_f32 v48, v64, v65
    v_cvt_pk_bf16_f32 v49, v66, v67
    v_cvt_pk_bf16_f32 v44, v80, v81
    v_cvt_pk_bf16_f32 v45, v82, v83
    v_lshlrev_b32 v80, 16, v44
    v_and_b32 v81, 0xffff0000, v44
    v_lshlrev_b32 v82, 16, v45
    v_and_b32 v83, 0xffff0000, v45
    v_pk_add_f32 v[80:81], v[80:81], v[36:37]
    v_pk_add_f32 v[82:83], v[82:83], v[38:39]
    v_cvt_pk_bf16_f32 v44, v80, v81
    v_cvt_pk_bf16_f32 v45, v82, v83
    v_lshlrev_b32 v80, 16, v44
    v_and_b32 v81, 0xffff0000, v44
    v_lshlrev_b32 v82, 16, v45
    v_and_b32 v83, 0xffff0000, v45
    v_pk_mul_f32 v[44:45], v[80:81], v[80:81]
    v_pk_mul_f32 v[46:47], v[82:83], v[82:83]
    v_pk_fma_f32 v[44:45], v[44:45], s[44:45], v[56:57]
    v_pk_fma_f32 v[46:47], v[46:47], s[44:45], v[56:57]
    v_pk_mul_f32 v[44:45], v[44:45], v[80:81]
    v_pk_mul_f32 v[46:47], v[46:47], v[82:83]
    v_exp_f32 v44, v44
    v_exp_f32 v45, v45
    v_exp_f32 v46, v46
    v_exp_f32 v47, v47
    s_nop 0
    v_pk_add_f32 v[44:45], v[44:45], v[58:59]
    v_pk_add_f32 v[46:47], v[46:47], v[58:59]
    v_rcp_f32 v44, v44
    v_rcp_f32 v45, v45
    v_rcp_f32 v46, v46
    v_rcp_f32 v47, v47
    s_nop 0
    v_pk_mul_f32 v[80:81], v[80:81], v[44:45]
    v_pk_mul_f32 v[82:83], v[82:83], v[46:47]
    v_cvt_pk_bf16_f32 v50, v80, v81
    v_cvt_pk_bf16_f32 v51, v82, v83
    buffer_store_dwordx4 v[48:51], v25, s[28:31], 0 offen offset:0
    v_cvt_pk_bf16_f32 v40, v68, v69
    v_cvt_pk_bf16_f32 v41, v70, v71
    v_lshlrev_b32 v68, 16, v40
    v_and_b32 v69, 0xffff0000, v40
    v_lshlrev_b32 v70, 16, v41
    v_and_b32 v71, 0xffff0000, v41
    v_pk_add_f32 v[68:69], v[68:69], v[32:33]
    v_pk_add_f32 v[70:71], v[70:71], v[34:35]
    v_cvt_pk_bf16_f32 v40, v68, v69
    v_cvt_pk_bf16_f32 v41, v70, v71
    v_lshlrev_b32 v68, 16, v40
    v_and_b32 v69, 0xffff0000, v40
    v_lshlrev_b32 v70, 16, v41
    v_and_b32 v71, 0xffff0000, v41
    v_pk_mul_f32 v[40:41], v[68:69], v[68:69]
    v_pk_mul_f32 v[42:43], v[70:71], v[70:71]
    v_pk_fma_f32 v[40:41], v[40:41], s[44:45], v[56:57]
    v_pk_fma_f32 v[42:43], v[42:43], s[44:45], v[56:57]
    v_pk_mul_f32 v[40:41], v[40:41], v[68:69]
    v_pk_mul_f32 v[42:43], v[42:43], v[70:71]
    v_exp_f32 v40, v40
    v_exp_f32 v41, v41
    v_exp_f32 v42, v42
    v_exp_f32 v43, v43
    s_nop 0
    v_pk_add_f32 v[40:41], v[40:41], v[58:59]
    v_pk_add_f32 v[42:43], v[42:43], v[58:59]
    v_rcp_f32 v40, v40
    v_rcp_f32 v41, v41
    v_rcp_f32 v42, v42
    v_rcp_f32 v43, v43
    s_nop 0
    v_pk_mul_f32 v[68:69], v[68:69], v[40:41]
    v_pk_mul_f32 v[70:71], v[70:71], v[42:43]
    v_cvt_pk_bf16_f32 v52, v68, v69
    v_cvt_pk_bf16_f32 v53, v70, v71
    v_cvt_pk_bf16_f32 v44, v84, v85
    v_cvt_pk_bf16_f32 v45, v86, v87
    v_lshlrev_b32 v84, 16, v44
    v_and_b32 v85, 0xffff0000, v44
    v_lshlrev_b32 v86, 16, v45
    v_and_b32 v87, 0xffff0000, v45
    v_pk_add_f32 v[84:85], v[84:85], v[36:37]
    v_pk_add_f32 v[86:87], v[86:87], v[38:39]
    v_cvt_pk_bf16_f32 v44, v84, v85
    v_cvt_pk_bf16_f32 v45, v86, v87
    v_lshlrev_b32 v84, 16, v44
    v_and_b32 v85, 0xffff0000, v44
    v_lshlrev_b32 v86, 16, v45
    v_and_b32 v87, 0xffff0000, v45
    v_pk_mul_f32 v[44:45], v[84:85], v[84:85]
    v_pk_mul_f32 v[46:47], v[86:87], v[86:87]
    v_pk_fma_f32 v[44:45], v[44:45], s[44:45], v[56:57]
    v_pk_fma_f32 v[46:47], v[46:47], s[44:45], v[56:57]
    v_pk_mul_f32 v[44:45], v[44:45], v[84:85]
    v_pk_mul_f32 v[46:47], v[46:47], v[86:87]
    v_exp_f32 v44, v44
    v_exp_f32 v45, v45
    v_exp_f32 v46, v46
    v_exp_f32 v47, v47
    s_nop 0
    v_pk_add_f32 v[44:45], v[44:45], v[58:59]
    v_pk_add_f32 v[46:47], v[46:47], v[58:59]
    v_rcp_f32 v44, v44
    v_rcp_f32 v45, v45
    v_rcp_f32 v46, v46
    v_rcp_f32 v47, v47
    s_nop 0
    v_pk_mul_f32 v[84:85], v[84:85], v[44:45]
    v_pk_mul_f32 v[86:87], v[86:87], v[46:47]
    v_cvt_pk_bf16_f32 v54, v84, v85
    v_cvt_pk_bf16_f32 v55, v86, v87
    buffer_store_dwordx4 v[52:55], v25, s[28:31], 0 offen offset:1024
    v_cvt_pk_bf16_f32 v40, v72, v73
    v_cvt_pk_bf16_f32 v41, v74, v75
    v_lshlrev_b32 v72, 16, v40
    v_and_b32 v73, 0xffff0000, v40
    v_lshlrev_b32 v74, 16, v41
    v_and_b32 v75, 0xffff0000, v41
    v_pk_add_f32 v[72:73], v[72:73], v[32:33]
    v_pk_add_f32 v[74:75], v[74:75], v[34:35]
    v_cvt_pk_bf16_f32 v40, v72, v73
    v_cvt_pk_bf16_f32 v41, v74, v75
    v_lshlrev_b32 v72, 16, v40
    v_and_b32 v73, 0xffff0000, v40
    v_lshlrev_b32 v74, 16, v41
    v_and_b32 v75, 0xffff0000, v41
    v_pk_mul_f32 v[40:41], v[72:73], v[72:73]
    v_pk_mul_f32 v[42:43], v[74:75], v[74:75]
    v_pk_fma_f32 v[40:41], v[40:41], s[44:45], v[56:57]
    v_pk_fma_f32 v[42:43], v[42:43], s[44:45], v[56:57]
    v_pk_mul_f32 v[40:41], v[40:41], v[72:73]
    v_pk_mul_f32 v[42:43], v[42:43], v[74:75]
    v_exp_f32 v40, v40
    v_exp_f32 v41, v41
    v_exp_f32 v42, v42
    v_exp_f32 v43, v43
    s_nop 0
    v_pk_add_f32 v[40:41], v[40:41], v[58:59]
    v_pk_add_f32 v[42:43], v[42:43], v[58:59]
    v_rcp_f32 v40, v40
    v_rcp_f32 v41, v41
    v_rcp_f32 v42, v42
    v_rcp_f32 v43, v43
    s_nop 0
    v_pk_mul_f32 v[72:73], v[72:73], v[40:41]
    v_pk_mul_f32 v[74:75], v[74:75], v[42:43]
    v_cvt_pk_bf16_f32 v48, v72, v73
    v_cvt_pk_bf16_f32 v49, v74, v75
    v_cvt_pk_bf16_f32 v44, v88, v89
    v_cvt_pk_bf16_f32 v45, v90, v91
    v_lshlrev_b32 v88, 16, v44
    v_and_b32 v89, 0xffff0000, v44
    v_lshlrev_b32 v90, 16, v45
    v_and_b32 v91, 0xffff0000, v45
    v_pk_add_f32 v[88:89], v[88:89], v[36:37]
    v_pk_add_f32 v[90:91], v[90:91], v[38:39]
    v_cvt_pk_bf16_f32 v44, v88, v89
    v_cvt_pk_bf16_f32 v45, v90, v91
    v_lshlrev_b32 v88, 16, v44
    v_and_b32 v89, 0xffff0000, v44
    v_lshlrev_b32 v90, 16, v45
    v_and_b32 v91, 0xffff0000, v45
    v_pk_mul_f32 v[44:45], v[88:89], v[88:89]
    v_pk_mul_f32 v[46:47], v[90:91], v[90:91]
    v_pk_fma_f32 v[44:45], v[44:45], s[44:45], v[56:57]
    v_pk_fma_f32 v[46:47], v[46:47], s[44:45], v[56:57]
    v_pk_mul_f32 v[44:45], v[44:45], v[88:89]
    v_pk_mul_f32 v[46:47], v[46:47], v[90:91]
    v_exp_f32 v44, v44
    v_exp_f32 v45, v45
    v_exp_f32 v46, v46
    v_exp_f32 v47, v47
    s_nop 0
    v_pk_add_f32 v[44:45], v[44:45], v[58:59]
    v_pk_add_f32 v[46:47], v[46:47], v[58:59]
    v_rcp_f32 v44, v44
    v_rcp_f32 v45, v45
    v_rcp_f32 v46, v46
    v_rcp_f32 v47, v47
    s_nop 0
    v_pk_mul_f32 v[88:89], v[88:89], v[44:45]
    v_pk_mul_f32 v[90:91], v[90:91], v[46:47]
    v_cvt_pk_bf16_f32 v50, v88, v89
    v_cvt_pk_bf16_f32 v51, v90, v91
    buffer_store_dwordx4 v[48:51], v25, s[28:31], 0 offen offset:2048
    v_cvt_pk_bf16_f32 v40, v76, v77
    v_cvt_pk_bf16_f32 v41, v78, v79
    v_lshlrev_b32 v76, 16, v40
    v_and_b32 v77, 0xffff0000, v40
    v_lshlrev_b32 v78, 16, v41
    v_and_b32 v79, 0xffff0000, v41
    v_pk_add_f32 v[76:77], v[76:77], v[32:33]
    v_pk_add_f32 v[78:79], v[78:79], v[34:35]
    v_cvt_pk_bf16_f32 v40, v76, v77
    v_cvt_pk_bf16_f32 v41, v78, v79
    v_lshlrev_b32 v76, 16, v40
    v_and_b32 v77, 0xffff0000, v40
    v_lshlrev_b32 v78, 16, v41
    v_and_b32 v79, 0xffff0000, v41
    v_pk_mul_f32 v[40:41], v[76:77], v[76:77]
    v_pk_mul_f32 v[42:43], v[78:79], v[78:79]
    v_pk_fma_f32 v[40:41], v[40:41], s[44:45], v[56:57]
    v_pk_fma_f32 v[42:43], v[42:43], s[44:45], v[56:57]
    v_pk_mul_f32 v[40:41], v[40:41], v[76:77]
    v_pk_mul_f32 v[42:43], v[42:43], v[78:79]
    v_exp_f32 v40, v40
    v_exp_f32 v41, v41
    v_exp_f32 v42, v42
    v_exp_f32 v43, v43
    s_nop 0
    v_pk_add_f32 v[40:41], v[40:41], v[58:59]
    v_pk_add_f32 v[42:43], v[42:43], v[58:59]
    v_rcp_f32 v40, v40
    v_rcp_f32 v41, v41
    v_rcp_f32 v42, v42
    v_rcp_f32 v43, v43
    s_nop 0
    v_pk_mul_f32 v[76:77], v[76:77], v[40:41]
    v_pk_mul_f32 v[78:79], v[78:79], v[42:43]
    v_cvt_pk_bf16_f32 v52, v76, v77
    v_cvt_pk_bf16_f32 v53, v78, v79
    v_cvt_pk_bf16_f32 v44, v92, v93
    v_cvt_pk_bf16_f32 v45, v94, v95
    v_lshlrev_b32 v92, 16, v44
    v_and_b32 v93, 0xffff0000, v44
    v_lshlrev_b32 v94, 16, v45
    v_and_b32 v95, 0xffff0000, v45
    v_pk_add_f32 v[92:93], v[92:93], v[36:37]
    v_pk_add_f32 v[94:95], v[94:95], v[38:39]
    v_cvt_pk_bf16_f32 v44, v92, v93
    v_cvt_pk_bf16_f32 v45, v94, v95
    v_lshlrev_b32 v92, 16, v44
    v_and_b32 v93, 0xffff0000, v44
    v_lshlrev_b32 v94, 16, v45
    v_and_b32 v95, 0xffff0000, v45
    v_pk_mul_f32 v[44:45], v[92:93], v[92:93]
    v_pk_mul_f32 v[46:47], v[94:95], v[94:95]
    v_pk_fma_f32 v[44:45], v[44:45], s[44:45], v[56:57]
    v_pk_fma_f32 v[46:47], v[46:47], s[44:45], v[56:57]
    v_pk_mul_f32 v[44:45], v[44:45], v[92:93]
    v_pk_mul_f32 v[46:47], v[46:47], v[94:95]
    v_exp_f32 v44, v44
    v_exp_f32 v45, v45
    v_exp_f32 v46, v46
    v_exp_f32 v47, v47
    s_nop 0
    v_pk_add_f32 v[44:45], v[44:45], v[58:59]
    v_pk_add_f32 v[46:47], v[46:47], v[58:59]
    v_rcp_f32 v44, v44
    v_rcp_f32 v45, v45
    v_rcp_f32 v46, v46
    v_rcp_f32 v47, v47
    s_nop 0
    v_pk_mul_f32 v[92:93], v[92:93], v[44:45]
    v_pk_mul_f32 v[94:95], v[94:95], v[46:47]
    v_cvt_pk_bf16_f32 v54, v92, v93
    v_cvt_pk_bf16_f32 v55, v94, v95
    buffer_store_dwordx4 v[52:55], v25, s[28:31], 0 offen offset:3072
    s_endpgm
g1_convw:
    s_sub_u32 s16, s16, 8
    s_lshl_b32 s64, s2, 2
    s_add_u32 s64, s64, s16
    s_lshl_b32 s65, s64, 12
    s_add_u32 s48, s68, s65
    s_addc_u32 s49, s69, 0
    s_movk_i32 s50, 4096
    s_mov_b32 s51, 0x00020000
    s_add_u32 s52, s8, s65
    s_addc_u32 s53, s9, 0
    s_add_u32 s56, s52, 12582912
    s_addc_u32 s57, s53, 0
    s_movk_i32 s58, 4096
    s_mov_b32 s59, 0x00020000
    s_add_u32 s52, s52, 8388608
    s_addc_u32 s53, s53, 0
    s_movk_i32 s54, 4096
    s_mov_b32 s55, 0x00020000
    s_mov_b32 s60, s70
    s_mov_b32 s61, s71
    s_mov_b32 s62, 2048
    s_mov_b32 s63, 0x00020000
    s_mul_i32 s66, s16, 12928
    s_add_u32 s66, s66, 98304
    v_lshlrev_b32 v21, 4, v1
    s_add_u32 m0, s66, 480
    s_nop 0
    buffer_load_dwordx4 v21, s[52:55], 0 offen offset:0 lds
    buffer_load_dwordx4 v21, s[52:55], 0 offen offset:1024 lds
    buffer_load_dwordx4 v21, s[52:55], 0 offen offset:2048 lds
    buffer_load_dwordx4 v21, s[52:55], 0 offen offset:3072 lds
    v_lshlrev_b32 v22, 6, v1
    v_subrev_u32 v22, 32, v22
    v_add_u32 v23, 0, v22
    buffer_load_dwordx4 v[64:67], v23, s[48:51], 0 offen
    v_add_u32 v23, 16, v22
    buffer_load_dwordx4 v[68:71], v23, s[48:51], 0 offen
    v_add_u32 v23, 32, v22
    buffer_load_dwordx4 v[72:75], v23, s[48:51], 0 offen
    v_add_u32 v23, 48, v22
    buffer_load_dwordx4 v[76:79], v23, s[48:51], 0 offen
    v_add_u32 v23, 64, v22
    buffer_load_dword v80, v23, s[48:51], 0 offen
    v_mov_b32 v23, 4064
    buffer_load_dwordx4 v[84:87], v23, s[48:51], 0 offen
    buffer_load_dwordx4 v[88:91], v23, s[48:51], 0 offen offset:16
    v_mov_b32 v92, 0
    s_lshl_b32 s65, s64, 1
    v_mov_b32 v22, s65
    buffer_load_ushort v20, v22, s[60:63], 0 offen
    v_mov_b32 v32, 0
    v_mov_b32 v33, 0
    v_mov_b32 v34, 0
    v_mov_b32 v35, 0
    v_add_u32 v22, s66, v21
    v_cmp_gt_u32 vcc, 30, v1
    s_and_saveexec_b64 s[72:73], vcc
    ds_write_b128 v22, v[32:35]
    s_mov_b64 exec, s[72:73]
    v_and_b32 v22, 15, v1
    v_lshrrev_b32 v23, 4, v1
    v_add_u32 v16, 1, v22
    v_and_b32 v16, 1, v16
    v_lshlrev_b32 v17, 3, v23
    v_sub_u32 v17, v22, v17
    v_sub_u32 v17, v17, v16
    v_lshlrev_b32 v17, 1, v17
    v_mul_u32_u24 v16, 4160, v16
    v_add_u32 v16, v16, v17
    v_add_u32 v16, s66, v16
    v_add_u32 v24, 4658, v16
    v_add_u32 v25, 5682, v16
    v_add_u32 v26, 6706, v16
    v_add_u32 v27, 7730, v16
    v_lshlrev_b32 v17, 5, v22
    v_lshl_add_u32 v17, v23, 4, v17
    v_add_u32 v17, s66, v17
    v_and_b32 v18, 1, v23
    v_lshlrev_b32 v18, 3, v18
    v_lshrrev_b32 v19, 1, v23
    v_lshlrev_b32 v19, 4, v19
    v_lshl_add_u32 v19, v22, 5, v19
    v_sub_u32 v18, v19, v18
    v_add_u32 v18, s66, v18
    v_add_u32 v18, 488, v18
    v_lshlrev_b32 v19, 5, v22
    v_lshl_add_u32 v19, v23, 3, v19
    s_barrier
    s_barrier
    s_barrier
    s_barrier
    s_waitcnt vmcnt(0)
    v_mov_b32 v32, 0
    v_mov_b32 v33, 0
    v_mov_b32 v34, 0
    v_mov_b32 v35, 0
    v_mov_b32 v36, 0
    v_mov_b32 v37, 0
    v_mov_b32 v38, 0
    v_mov_b32 v39, 0
    v_mov_b32 v40, 0
    v_mov_b32 v41, 0
    v_mov_b32 v42, 0
    v_mov_b32 v43, 0
    v_mov_b32 v44, 0
    v_mov_b32 v45, 0
    v_mov_b32 v46, 0
    v_mov_b32 v47, 0
    v_mov_b32 v48, 0
    v_mov_b32 v49, 0
    v_mov_b32 v50, 0
    v_mov_b32 v51, 0
    v_mov_b32 v52, 0
    v_mov_b32 v53, 0
    v_mov_b32 v54, 0
    v_mov_b32 v55, 0
    v_mov_b32 v56, 0
    v_mov_b32 v57, 0
    v_mov_b32 v58, 0
    v_mov_b32 v59, 0
    v_mov_b32 v60, 0
    v_mov_b32 v61, 0
    v_mov_b32 v62, 0
    v_mov_b32 v63, 0
    v_lshlrev_b32 v21, 6, v1
    v_add_u32 v21, s66, v21
    v_alignbit_b32 v96, v65, v64, 16
    v_alignbit_b32 v97, v66, v65, 16
    v_alignbit_b32 v98, v67, v66, 16
    v_alignbit_b32 v99, v68, v67, 16
    v_alignbit_b32 v100, v69, v68, 16
    v_alignbit_b32 v101, v70, v69, 16
    v_alignbit_b32 v102, v71, v70, 16
    v_alignbit_b32 v103, v72, v71, 16
    v_alignbit_b32 v104, v73, v72, 16
    v_alignbit_b32 v105, v74, v73, 16
    v_alignbit_b32 v106, v75, v74, 16
    v_alignbit_b32 v107, v76, v75, 16
    v_alignbit_b32 v108, v77, v76, 16
    v_alignbit_b32 v109, v78, v77, 16
    v_alignbit_b32 v110, v79, v78, 16
    v_alignbit_b32 v111, v80, v79, 16
    ds_write_b128 v21, v[64:67] offset:4608
    ds_write_b128 v21, v[96:99] offset:8768
    ds_write_b128 v21, v[68:71] offset:4624
    ds_write_b128 v21, v[100:103] offset:8784
    ds_write_b128 v21, v[72:75] offset:4640
    ds_write_b128 v21, v[104:107] offset:8800
    ds_write_b128 v21, v[76:79] offset:4656
    ds_write_b128 v21, v[108:111] offset:8816
    v_alignbit_b32 v112, v85, v84, 16
    v_alignbit_b32 v113, v86, v85, 16
    v_alignbit_b32 v114, v87, v86, 16
    v_alignbit_b32 v115, v88, v87, 16
    v_alignbit_b32 v116, v89, v88, 16
    v_alignbit_b32 v117, v90, v89, 16
    v_alignbit_b32 v118, v91, v90, 16
    v_alignbit_b32 v119, v92, v91, 16
    v_cmp_eq_u32 vcc, 0, v1
    s_and_saveexec_b64 s[72:73], vcc
    ds_write_b128 v21, v[84:87] offset:8704
    ds_write_b128 v21, v[112:115] offset:12864
    ds_write_b128 v21, v[88:91] offset:8720
    ds_write_b128 v21, v[116:119] offset:12880
    s_mov_b64 exec, s[72:73]
    s_waitcnt lgkmcnt(0)
    s_barrier
    ds_read2_b32 v[64:65], v24 offset0:0 offset1:1
    ds_read2_b32 v[66:67], v24 offset0:2 offset1:3
    ds_read_b128 v[96:99], v17 offset:448
    ds_read2_b32 v[68:69], v24 offset0:128 offset1:129
    ds_read2_b32 v[70:71], v24 offset0:130 offset1:131
    ds_read_b128 v[100:103], v17 offset:960
    ds_read2_b32 v[72:73], v25 offset0:0 offset1:1
    ds_read2_b32 v[74:75], v25 offset0:2 offset1:3
    ds_read_b128 v[104:107], v17 offset:1472
    ds_read2_b32 v[76:77], v25 offset0:128 offset1:129
    ds_read2_b32 v[78:79], v25 offset0:130 offset1:131
    ds_read_b128 v[108:111], v17 offset:1984
    ds_read2_b32 v[80:81], v26 offset0:0 offset1:1
    ds_read2_b32 v[82:83], v26 offset0:2 offset1:3
    ds_read_b128 v[112:115], v17 offset:2496
    ds_read2_b32 v[84:85], v26 offset0:128 offset1:129
    ds_read2_b32 v[86:87], v26 offset0:130 offset1:131
    ds_read_b128 v[116:119], v17 offset:3008
    ds_read2_b32 v[88:89], v27 offset0:0 offset1:1
    ds_read2_b32 v[90:91], v27 offset0:2 offset1:3
    ds_read_b128 v[120:123], v17 offset:3520
    ds_read2_b32 v[92:93], v27 offset0:128 offset1:129
    ds_read2_b32 v[94:95], v27 offset0:130 offset1:131
    ds_read_b128 v[124:127], v17 offset:4032
    s_waitcnt lgkmcnt(0)
    v_mfma_f32_16x16x32_bf16 v[32:35], v[64:67], v[96:99], v[32:35]
    v_mfma_f32_16x16x32_bf16 v[36:39], v[64:67], v[100:103], v[36:39]
    s_barrier
    v_mfma_f32_16x16x32_bf16 v[40:43], v[64:67], v[104:107], v[40:43]
    v_mfma_f32_16x16x32_bf16 v[44:47], v[64:67], v[108:111], v[44:47]
    v_mfma_f32_16x16x32_bf16 v[48:51], v[64:67], v[112:115], v[48:51]
    v_mfma_f32_16x16x32_bf16 v[52:55], v[64:67], v[116:119], v[52:55]
    v_mfma_f32_16x16x32_bf16 v[56:59], v[64:67], v[120:123], v[56:59]
    v_mfma_f32_16x16x32_bf16 v[60:63], v[64:67], v[124:127], v[60:63]
    v_mfma_f32_16x16x32_bf16 v[36:39], v[68:71], v[96:99], v[36:39]
    v_mfma_f32_16x16x32_bf16 v[40:43], v[68:71], v[100:103], v[40:43]
    v_mfma_f32_16x16x32_bf16 v[44:47], v[68:71], v[104:107], v[44:47]
    v_mfma_f32_16x16x32_bf16 v[48:51], v[68:71], v[108:111], v[48:51]
    v_mfma_f32_16x16x32_bf16 v[52:55], v[68:71], v[112:115], v[52:55]
    v_mfma_f32_16x16x32_bf16 v[56:59], v[68:71], v[116:119], v[56:59]
    v_mfma_f32_16x16x32_bf16 v[60:63], v[68:71], v[120:123], v[60:63]
    v_mfma_f32_16x16x32_bf16 v[40:43], v[72:75], v[96:99], v[40:43]
    v_mfma_f32_16x16x32_bf16 v[44:47], v[72:75], v[100:103], v[44:47]
    v_mfma_f32_16x16x32_bf16 v[48:51], v[72:75], v[104:107], v[48:51]
    v_mfma_f32_16x16x32_bf16 v[52:55], v[72:75], v[108:111], v[52:55]
    v_mfma_f32_16x16x32_bf16 v[56:59], v[72:75], v[112:115], v[56:59]
    v_mfma_f32_16x16x32_bf16 v[60:63], v[72:75], v[116:119], v[60:63]
    v_mfma_f32_16x16x32_bf16 v[44:47], v[76:79], v[96:99], v[44:47]
    v_mfma_f32_16x16x32_bf16 v[48:51], v[76:79], v[100:103], v[48:51]
    v_mfma_f32_16x16x32_bf16 v[52:55], v[76:79], v[104:107], v[52:55]
    v_mfma_f32_16x16x32_bf16 v[56:59], v[76:79], v[108:111], v[56:59]
    v_mfma_f32_16x16x32_bf16 v[60:63], v[76:79], v[112:115], v[60:63]
    v_mfma_f32_16x16x32_bf16 v[48:51], v[80:83], v[96:99], v[48:51]
    v_mfma_f32_16x16x32_bf16 v[52:55], v[80:83], v[100:103], v[52:55]
    v_mfma_f32_16x16x32_bf16 v[56:59], v[80:83], v[104:107], v[56:59]
    s_barrier
    v_mfma_f32_16x16x32_bf16 v[60:63], v[80:83], v[108:111], v[60:63]
    v_mfma_f32_16x16x32_bf16 v[52:55], v[84:87], v[96:99], v[52:55]
    v_mfma_f32_16x16x32_bf16 v[56:59], v[84:87], v[100:103], v[56:59]
    v_mfma_f32_16x16x32_bf16 v[60:63], v[84:87], v[104:107], v[60:63]
    v_mfma_f32_16x16x32_bf16 v[56:59], v[88:91], v[96:99], v[56:59]
    v_mfma_f32_16x16x32_bf16 v[60:63], v[88:91], v[100:103], v[60:63]
    v_mfma_f32_16x16x32_bf16 v[60:63], v[92:95], v[96:99], v[60:63]
    ds_read2_b32 v[64:65], v24 offset0:16 offset1:17
    ds_read2_b32 v[66:67], v24 offset0:18 offset1:19
    ds_read_b128 v[96:99], v17 offset:384
    ds_read2_b32 v[68:69], v24 offset0:144 offset1:145
    ds_read2_b32 v[70:71], v24 offset0:146 offset1:147
    ds_read_b128 v[100:103], v17 offset:896
    ds_read2_b32 v[72:73], v25 offset0:16 offset1:17
    ds_read2_b32 v[74:75], v25 offset0:18 offset1:19
    ds_read_b128 v[104:107], v17 offset:1408
    ds_read2_b32 v[76:77], v25 offset0:144 offset1:145
    ds_read2_b32 v[78:79], v25 offset0:146 offset1:147
    ds_read_b128 v[108:111], v17 offset:1920
    ds_read2_b32 v[80:81], v26 offset0:16 offset1:17
    ds_read2_b32 v[82:83], v26 offset0:18 offset1:19
    ds_read_b128 v[112:115], v17 offset:2432
    ds_read2_b32 v[84:85], v26 offset0:144 offset1:145
    ds_read2_b32 v[86:87], v26 offset0:146 offset1:147
    ds_read_b128 v[116:119], v17 offset:2944
    ds_read2_b32 v[88:89], v27 offset0:16 offset1:17
    ds_read2_b32 v[90:91], v27 offset0:18 offset1:19
    s_barrier
    ds_read_b128 v[120:123], v17 offset:3456
    ds_read2_b32 v[92:93], v27 offset0:144 offset1:145
    ds_read2_b32 v[94:95], v27 offset0:146 offset1:147
    ds_read_b128 v[124:127], v17 offset:3968
    s_waitcnt lgkmcnt(0)
    v_mfma_f32_16x16x32_bf16 v[32:35], v[64:67], v[96:99], v[32:35]
    v_mfma_f32_16x16x32_bf16 v[36:39], v[64:67], v[100:103], v[36:39]
    v_mfma_f32_16x16x32_bf16 v[40:43], v[64:67], v[104:107], v[40:43]
    v_mfma_f32_16x16x32_bf16 v[44:47], v[64:67], v[108:111], v[44:47]
    v_mfma_f32_16x16x32_bf16 v[48:51], v[64:67], v[112:115], v[48:51]
    v_mfma_f32_16x16x32_bf16 v[52:55], v[64:67], v[116:119], v[52:55]
    v_mfma_f32_16x16x32_bf16 v[56:59], v[64:67], v[120:123], v[56:59]
    v_mfma_f32_16x16x32_bf16 v[60:63], v[64:67], v[124:127], v[60:63]
    v_mfma_f32_16x16x32_bf16 v[36:39], v[68:71], v[96:99], v[36:39]
    v_mfma_f32_16x16x32_bf16 v[40:43], v[68:71], v[100:103], v[40:43]
    v_mfma_f32_16x16x32_bf16 v[44:47], v[68:71], v[104:107], v[44:47]
    v_mfma_f32_16x16x32_bf16 v[48:51], v[68:71], v[108:111], v[48:51]
    v_mfma_f32_16x16x32_bf16 v[52:55], v[68:71], v[112:115], v[52:55]
    v_mfma_f32_16x16x32_bf16 v[56:59], v[68:71], v[116:119], v[56:59]
    v_mfma_f32_16x16x32_bf16 v[60:63], v[68:71], v[120:123], v[60:63]
    v_mfma_f32_16x16x32_bf16 v[40:43], v[72:75], v[96:99], v[40:43]
    v_mfma_f32_16x16x32_bf16 v[44:47], v[72:75], v[100:103], v[44:47]
    v_mfma_f32_16x16x32_bf16 v[48:51], v[72:75], v[104:107], v[48:51]
    v_mfma_f32_16x16x32_bf16 v[52:55], v[72:75], v[108:111], v[52:55]
    v_mfma_f32_16x16x32_bf16 v[56:59], v[72:75], v[112:115], v[56:59]
    v_mfma_f32_16x16x32_bf16 v[60:63], v[72:75], v[116:119], v[60:63]
    v_mfma_f32_16x16x32_bf16 v[44:47], v[76:79], v[96:99], v[44:47]
    s_barrier
    v_mfma_f32_16x16x32_bf16 v[48:51], v[76:79], v[100:103], v[48:51]
    v_mfma_f32_16x16x32_bf16 v[52:55], v[76:79], v[104:107], v[52:55]
    v_mfma_f32_16x16x32_bf16 v[56:59], v[76:79], v[108:111], v[56:59]
    v_mfma_f32_16x16x32_bf16 v[60:63], v[76:79], v[112:115], v[60:63]
    v_mfma_f32_16x16x32_bf16 v[48:51], v[80:83], v[96:99], v[48:51]
    v_mfma_f32_16x16x32_bf16 v[52:55], v[80:83], v[100:103], v[52:55]
    v_mfma_f32_16x16x32_bf16 v[56:59], v[80:83], v[104:107], v[56:59]
    v_mfma_f32_16x16x32_bf16 v[60:63], v[80:83], v[108:111], v[60:63]
    v_mfma_f32_16x16x32_bf16 v[52:55], v[84:87], v[96:99], v[52:55]
    v_mfma_f32_16x16x32_bf16 v[56:59], v[84:87], v[100:103], v[56:59]
    v_mfma_f32_16x16x32_bf16 v[60:63], v[84:87], v[104:107], v[60:63]
    v_mfma_f32_16x16x32_bf16 v[56:59], v[88:91], v[96:99], v[56:59]
    v_mfma_f32_16x16x32_bf16 v[60:63], v[88:91], v[100:103], v[60:63]
    v_mfma_f32_16x16x32_bf16 v[60:63], v[92:95], v[96:99], v[60:63]
    ds_read2_b32 v[64:65], v24 offset0:32 offset1:33
    ds_read2_b32 v[66:67], v24 offset0:34 offset1:35
    ds_read_b128 v[96:99], v17 offset:320
    ds_read2_b32 v[68:69], v24 offset0:160 offset1:161
    ds_read2_b32 v[70:71], v24 offset0:162 offset1:163
    ds_read_b128 v[100:103], v17 offset:832
    ds_read2_b32 v[72:73], v25 offset0:32 offset1:33
    ds_read2_b32 v[74:75], v25 offset0:34 offset1:35
    ds_read_b128 v[104:107], v17 offset:1344
    ds_read2_b32 v[76:77], v25 offset0:160 offset1:161
    ds_read2_b32 v[78:79], v25 offset0:162 offset1:163
    ds_read_b128 v[108:111], v17 offset:1856
    ds_read2_b32 v[80:81], v26 offset0:32 offset1:33
    s_barrier
    ds_read2_b32 v[82:83], v26 offset0:34 offset1:35
    ds_read_b128 v[112:115], v17 offset:2368
    ds_read2_b32 v[84:85], v26 offset0:160 offset1:161
    ds_read2_b32 v[86:87], v26 offset0:162 offset1:163
    ds_read_b128 v[116:119], v17 offset:2880
    ds_read2_b32 v[88:89], v27 offset0:32 offset1:33
    ds_read2_b32 v[90:91], v27 offset0:34 offset1:35
    ds_read_b128 v[120:123], v17 offset:3392
    ds_read2_b32 v[92:93], v27 offset0:160 offset1:161
    ds_read2_b32 v[94:95], v27 offset0:162 offset1:163
    ds_read_b128 v[124:127], v17 offset:3904
    s_waitcnt lgkmcnt(0)
    v_mfma_f32_16x16x32_bf16 v[32:35], v[64:67], v[96:99], v[32:35]
    v_mfma_f32_16x16x32_bf16 v[36:39], v[64:67], v[100:103], v[36:39]
    v_mfma_f32_16x16x32_bf16 v[40:43], v[64:67], v[104:107], v[40:43]
    v_mfma_f32_16x16x32_bf16 v[44:47], v[64:67], v[108:111], v[44:47]
    v_mfma_f32_16x16x32_bf16 v[48:51], v[64:67], v[112:115], v[48:51]
    v_mfma_f32_16x16x32_bf16 v[52:55], v[64:67], v[116:119], v[52:55]
    v_mfma_f32_16x16x32_bf16 v[56:59], v[64:67], v[120:123], v[56:59]
    v_mfma_f32_16x16x32_bf16 v[60:63], v[64:67], v[124:127], v[60:63]
    v_mfma_f32_16x16x32_bf16 v[36:39], v[68:71], v[96:99], v[36:39]
    v_mfma_f32_16x16x32_bf16 v[40:43], v[68:71], v[100:103], v[40:43]
    v_mfma_f32_16x16x32_bf16 v[44:47], v[68:71], v[104:107], v[44:47]
    v_mfma_f32_16x16x32_bf16 v[48:51], v[68:71], v[108:111], v[48:51]
    v_mfma_f32_16x16x32_bf16 v[52:55], v[68:71], v[112:115], v[52:55]
    v_mfma_f32_16x16x32_bf16 v[56:59], v[68:71], v[116:119], v[56:59]
    v_mfma_f32_16x16x32_bf16 v[60:63], v[68:71], v[120:123], v[60:63]
    s_barrier
    v_mfma_f32_16x16x32_bf16 v[40:43], v[72:75], v[96:99], v[40:43]
    v_mfma_f32_16x16x32_bf16 v[44:47], v[72:75], v[100:103], v[44:47]
    v_mfma_f32_16x16x32_bf16 v[48:51], v[72:75], v[104:107], v[48:51]
    v_mfma_f32_16x16x32_bf16 v[52:55], v[72:75], v[108:111], v[52:55]
    v_mfma_f32_16x16x32_bf16 v[56:59], v[72:75], v[112:115], v[56:59]
    v_mfma_f32_16x16x32_bf16 v[60:63], v[72:75], v[116:119], v[60:63]
    v_mfma_f32_16x16x32_bf16 v[44:47], v[76:79], v[96:99], v[44:47]
    v_mfma_f32_16x16x32_bf16 v[48:51], v[76:79], v[100:103], v[48:51]
    v_mfma_f32_16x16x32_bf16 v[52:55], v[76:79], v[104:107], v[52:55]
    v_mfma_f32_16x16x32_bf16 v[56:59], v[76:79], v[108:111], v[56:59]
    v_mfma_f32_16x16x32_bf16 v[60:63], v[76:79], v[112:115], v[60:63]
    v_mfma_f32_16x16x32_bf16 v[48:51], v[80:83], v[96:99], v[48:51]
    v_mfma_f32_16x16x32_bf16 v[52:55], v[80:83], v[100:103], v[52:55]
    v_mfma_f32_16x16x32_bf16 v[56:59], v[80:83], v[104:107], v[56:59]
    v_mfma_f32_16x16x32_bf16 v[60:63], v[80:83], v[108:111], v[60:63]
    v_mfma_f32_16x16x32_bf16 v[52:55], v[84:87], v[96:99], v[52:55]
    v_mfma_f32_16x16x32_bf16 v[56:59], v[84:87], v[100:103], v[56:59]
    v_mfma_f32_16x16x32_bf16 v[60:63], v[84:87], v[104:107], v[60:63]
    v_mfma_f32_16x16x32_bf16 v[56:59], v[88:91], v[96:99], v[56:59]
    v_mfma_f32_16x16x32_bf16 v[60:63], v[88:91], v[100:103], v[60:63]
    v_mfma_f32_16x16x32_bf16 v[60:63], v[92:95], v[96:99], v[60:63]
    ds_read2_b32 v[64:65], v24 offset0:48 offset1:49
    ds_read2_b32 v[66:67], v24 offset0:50 offset1:51
    ds_read_b128 v[96:99], v17 offset:256
    ds_read2_b32 v[68:69], v24 offset0:176 offset1:177
    ds_read2_b32 v[70:71], v24 offset0:178 offset1:179
    ds_read_b128 v[100:103], v17 offset:768
    s_barrier
    ds_read2_b32 v[72:73], v25 offset0:48 offset1:49
    ds_read2_b32 v[74:75], v25 offset0:50 offset1:51
    ds_read_b128 v[104:107], v17 offset:1280
    ds_read2_b32 v[76:77], v25 offset0:176 offset1:177
    ds_read2_b32 v[78:79], v25 offset0:178 offset1:179
    ds_read_b128 v[108:111], v17 offset:1792
    ds_read2_b32 v[80:81], v26 offset0:48 offset1:49
    ds_read2_b32 v[82:83], v26 offset0:50 offset1:51
    ds_read_b128 v[112:115], v17 offset:2304
    ds_read2_b32 v[84:85], v26 offset0:176 offset1:177
    ds_read2_b32 v[86:87], v26 offset0:178 offset1:179
    ds_read_b128 v[116:119], v17 offset:2816
    ds_read2_b32 v[88:89], v27 offset0:48 offset1:49
    ds_read2_b32 v[90:91], v27 offset0:50 offset1:51
    ds_read_b128 v[120:123], v17 offset:3328
    ds_read2_b32 v[92:93], v27 offset0:176 offset1:177
    ds_read2_b32 v[94:95], v27 offset0:178 offset1:179
    ds_read_b128 v[124:127], v17 offset:3840
    s_waitcnt lgkmcnt(0)
    v_mfma_f32_16x16x32_bf16 v[32:35], v[64:67], v[96:99], v[32:35]
    v_mfma_f32_16x16x32_bf16 v[36:39], v[64:67], v[100:103], v[36:39]
    v_mfma_f32_16x16x32_bf16 v[40:43], v[64:67], v[104:107], v[40:43]
    v_mfma_f32_16x16x32_bf16 v[44:47], v[64:67], v[108:111], v[44:47]
    v_mfma_f32_16x16x32_bf16 v[48:51], v[64:67], v[112:115], v[48:51]
    v_mfma_f32_16x16x32_bf16 v[52:55], v[64:67], v[116:119], v[52:55]
    v_mfma_f32_16x16x32_bf16 v[56:59], v[64:67], v[120:123], v[56:59]
    v_mfma_f32_16x16x32_bf16 v[60:63], v[64:67], v[124:127], v[60:63]
    s_barrier
    v_mfma_f32_16x16x32_bf16 v[36:39], v[68:71], v[96:99], v[36:39]
    v_mfma_f32_16x16x32_bf16 v[40:43], v[68:71], v[100:103], v[40:43]
    v_mfma_f32_16x16x32_bf16 v[44:47], v[68:71], v[104:107], v[44:47]
    v_mfma_f32_16x16x32_bf16 v[48:51], v[68:71], v[108:111], v[48:51]
    v_mfma_f32_16x16x32_bf16 v[52:55], v[68:71], v[112:115], v[52:55]
    v_mfma_f32_16x16x32_bf16 v[56:59], v[68:71], v[116:119], v[56:59]
    v_mfma_f32_16x16x32_bf16 v[60:63], v[68:71], v[120:123], v[60:63]
    v_mfma_f32_16x16x32_bf16 v[40:43], v[72:75], v[96:99], v[40:43]
    v_mfma_f32_16x16x32_bf16 v[44:47], v[72:75], v[100:103], v[44:47]
    v_mfma_f32_16x16x32_bf16 v[48:51], v[72:75], v[104:107], v[48:51]
    v_mfma_f32_16x16x32_bf16 v[52:55], v[72:75], v[108:111], v[52:55]
    v_mfma_f32_16x16x32_bf16 v[56:59], v[72:75], v[112:115], v[56:59]
    v_mfma_f32_16x16x32_bf16 v[60:63], v[72:75], v[116:119], v[60:63]
    v_mfma_f32_16x16x32_bf16 v[44:47], v[76:79], v[96:99], v[44:47]
    v_mfma_f32_16x16x32_bf16 v[48:51], v[76:79], v[100:103], v[48:51]
    v_mfma_f32_16x16x32_bf16 v[52:55], v[76:79], v[104:107], v[52:55]
    v_mfma_f32_16x16x32_bf16 v[56:59], v[76:79], v[108:111], v[56:59]
    v_mfma_f32_16x16x32_bf16 v[60:63], v[76:79], v[112:115], v[60:63]
    v_mfma_f32_16x16x32_bf16 v[48:51], v[80:83], v[96:99], v[48:51]
    v_mfma_f32_16x16x32_bf16 v[52:55], v[80:83], v[100:103], v[52:55]
    v_mfma_f32_16x16x32_bf16 v[56:59], v[80:83], v[104:107], v[56:59]
    v_mfma_f32_16x16x32_bf16 v[60:63], v[80:83], v[108:111], v[60:63]
    v_mfma_f32_16x16x32_bf16 v[52:55], v[84:87], v[96:99], v[52:55]
    v_mfma_f32_16x16x32_bf16 v[56:59], v[84:87], v[100:103], v[56:59]
    v_mfma_f32_16x16x32_bf16 v[60:63], v[84:87], v[104:107], v[60:63]
    v_mfma_f32_16x16x32_bf16 v[56:59], v[88:91], v[96:99], v[56:59]
    v_mfma_f32_16x16x32_bf16 v[60:63], v[88:91], v[100:103], v[60:63]
    s_barrier
    v_mfma_f32_16x16x32_bf16 v[60:63], v[92:95], v[96:99], v[60:63]
    ds_read2_b32 v[64:65], v24 offset0:64 offset1:65
    ds_read2_b32 v[66:67], v24 offset0:66 offset1:67
    ds_read_b128 v[96:99], v17 offset:192
    ds_read2_b32 v[68:69], v24 offset0:192 offset1:193
    ds_read2_b32 v[70:71], v24 offset0:194 offset1:195
    ds_read_b128 v[100:103], v17 offset:704
    ds_read2_b32 v[72:73], v25 offset0:64 offset1:65
    ds_read2_b32 v[74:75], v25 offset0:66 offset1:67
    ds_read_b128 v[104:107], v17 offset:1216
    ds_read2_b32 v[76:77], v25 offset0:192 offset1:193
    ds_read2_b32 v[78:79], v25 offset0:194 offset1:195
    ds_read_b128 v[108:111], v17 offset:1728
    ds_read2_b32 v[80:81], v26 offset0:64 offset1:65
    ds_read2_b32 v[82:83], v26 offset0:66 offset1:67
    ds_read_b128 v[112:115], v17 offset:2240
    ds_read2_b32 v[84:85], v26 offset0:192 offset1:193
    ds_read2_b32 v[86:87], v26 offset0:194 offset1:195
    ds_read_b128 v[116:119], v17 offset:2752
    ds_read2_b32 v[88:89], v27 offset0:64 offset1:65
    ds_read2_b32 v[90:91], v27 offset0:66 offset1:67
    ds_read_b128 v[120:123], v17 offset:3264
    ds_read2_b32 v[92:93], v27 offset0:192 offset1:193
    ds_read2_b32 v[94:95], v27 offset0:194 offset1:195
    ds_read_b128 v[124:127], v17 offset:3776
    s_waitcnt lgkmcnt(0)
    v_mfma_f32_16x16x32_bf16 v[32:35], v[64:67], v[96:99], v[32:35]
    s_barrier
    v_mfma_f32_16x16x32_bf16 v[36:39], v[64:67], v[100:103], v[36:39]
    v_mfma_f32_16x16x32_bf16 v[40:43], v[64:67], v[104:107], v[40:43]
    v_mfma_f32_16x16x32_bf16 v[44:47], v[64:67], v[108:111], v[44:47]
    v_mfma_f32_16x16x32_bf16 v[48:51], v[64:67], v[112:115], v[48:51]
    v_mfma_f32_16x16x32_bf16 v[52:55], v[64:67], v[116:119], v[52:55]
    v_mfma_f32_16x16x32_bf16 v[56:59], v[64:67], v[120:123], v[56:59]
    v_mfma_f32_16x16x32_bf16 v[60:63], v[64:67], v[124:127], v[60:63]
    v_mfma_f32_16x16x32_bf16 v[36:39], v[68:71], v[96:99], v[36:39]
    v_mfma_f32_16x16x32_bf16 v[40:43], v[68:71], v[100:103], v[40:43]
    v_mfma_f32_16x16x32_bf16 v[44:47], v[68:71], v[104:107], v[44:47]
    v_mfma_f32_16x16x32_bf16 v[48:51], v[68:71], v[108:111], v[48:51]
    v_mfma_f32_16x16x32_bf16 v[52:55], v[68:71], v[112:115], v[52:55]
    v_mfma_f32_16x16x32_bf16 v[56:59], v[68:71], v[116:119], v[56:59]
    v_mfma_f32_16x16x32_bf16 v[60:63], v[68:71], v[120:123], v[60:63]
    v_mfma_f32_16x16x32_bf16 v[40:43], v[72:75], v[96:99], v[40:43]
    v_mfma_f32_16x16x32_bf16 v[44:47], v[72:75], v[100:103], v[44:47]
    v_mfma_f32_16x16x32_bf16 v[48:51], v[72:75], v[104:107], v[48:51]
    v_mfma_f32_16x16x32_bf16 v[52:55], v[72:75], v[108:111], v[52:55]
    v_mfma_f32_16x16x32_bf16 v[56:59], v[72:75], v[112:115], v[56:59]
    v_mfma_f32_16x16x32_bf16 v[60:63], v[72:75], v[116:119], v[60:63]
    v_mfma_f32_16x16x32_bf16 v[44:47], v[76:79], v[96:99], v[44:47]
    v_mfma_f32_16x16x32_bf16 v[48:51], v[76:79], v[100:103], v[48:51]
    v_mfma_f32_16x16x32_bf16 v[52:55], v[76:79], v[104:107], v[52:55]
    v_mfma_f32_16x16x32_bf16 v[56:59], v[76:79], v[108:111], v[56:59]
    v_mfma_f32_16x16x32_bf16 v[60:63], v[76:79], v[112:115], v[60:63]
    v_mfma_f32_16x16x32_bf16 v[48:51], v[80:83], v[96:99], v[48:51]
    v_mfma_f32_16x16x32_bf16 v[52:55], v[80:83], v[100:103], v[52:55]
    s_barrier
    v_mfma_f32_16x16x32_bf16 v[56:59], v[80:83], v[104:107], v[56:59]
    v_mfma_f32_16x16x32_bf16 v[60:63], v[80:83], v[108:111], v[60:63]
    v_mfma_f32_16x16x32_bf16 v[52:55], v[84:87], v[96:99], v[52:55]
    v_mfma_f32_16x16x32_bf16 v[56:59], v[84:87], v[100:103], v[56:59]
    v_mfma_f32_16x16x32_bf16 v[60:63], v[84:87], v[104:107], v[60:63]
    v_mfma_f32_16x16x32_bf16 v[56:59], v[88:91], v[96:99], v[56:59]
    v_mfma_f32_16x16x32_bf16 v[60:63], v[88:91], v[100:103], v[60:63]
    v_mfma_f32_16x16x32_bf16 v[60:63], v[92:95], v[96:99], v[60:63]
    ds_read2_b32 v[64:65], v24 offset0:80 offset1:81
    ds_read2_b32 v[66:67], v24 offset0:82 offset1:83
    ds_read_b128 v[96:99], v17 offset:128
    ds_read2_b32 v[68:69], v24 offset0:208 offset1:209
    ds_read2_b32 v[70:71], v24 offset0:210 offset1:211
    ds_read_b128 v[100:103], v17 offset:640
    ds_read2_b32 v[72:73], v25 offset0:80 offset1:81
    ds_read2_b32 v[74:75], v25 offset0:82 offset1:83
    ds_read_b128 v[104:107], v17 offset:1152
    ds_read2_b32 v[76:77], v25 offset0:208 offset1:209
    ds_read2_b32 v[78:79], v25 offset0:210 offset1:211
    ds_read_b128 v[108:111], v17 offset:1664
    ds_read2_b32 v[80:81], v26 offset0:80 offset1:81
    ds_read2_b32 v[82:83], v26 offset0:82 offset1:83
    ds_read_b128 v[112:115], v17 offset:2176
    ds_read2_b32 v[84:85], v26 offset0:208 offset1:209
    ds_read2_b32 v[86:87], v26 offset0:210 offset1:211
    ds_read_b128 v[116:119], v17 offset:2688
    ds_read2_b32 v[88:89], v27 offset0:80 offset1:81
    s_barrier
    ds_read2_b32 v[90:91], v27 offset0:82 offset1:83
    ds_read_b128 v[120:123], v17 offset:3200
    ds_read2_b32 v[92:93], v27 offset0:208 offset1:209
    ds_read2_b32 v[94:95], v27 offset0:210 offset1:211
    ds_read_b128 v[124:127], v17 offset:3712
    s_waitcnt lgkmcnt(0)
    v_mfma_f32_16x16x32_bf16 v[32:35], v[64:67], v[96:99], v[32:35]
    v_mfma_f32_16x16x32_bf16 v[36:39], v[64:67], v[100:103], v[36:39]
    v_mfma_f32_16x16x32_bf16 v[40:43], v[64:67], v[104:107], v[40:43]
    v_mfma_f32_16x16x32_bf16 v[44:47], v[64:67], v[108:111], v[44:47]
    v_mfma_f32_16x16x32_bf16 v[48:51], v[64:67], v[112:115], v[48:51]
    v_mfma_f32_16x16x32_bf16 v[52:55], v[64:67], v[116:119], v[52:55]
    v_mfma_f32_16x16x32_bf16 v[56:59], v[64:67], v[120:123], v[56:59]
    v_mfma_f32_16x16x32_bf16 v[60:63], v[64:67], v[124:127], v[60:63]
    v_mfma_f32_16x16x32_bf16 v[36:39], v[68:71], v[96:99], v[36:39]
    v_mfma_f32_16x16x32_bf16 v[40:43], v[68:71], v[100:103], v[40:43]
    v_mfma_f32_16x16x32_bf16 v[44:47], v[68:71], v[104:107], v[44:47]
    v_mfma_f32_16x16x32_bf16 v[48:51], v[68:71], v[108:111], v[48:51]
    v_mfma_f32_16x16x32_bf16 v[52:55], v[68:71], v[112:115], v[52:55]
    v_mfma_f32_16x16x32_bf16 v[56:59], v[68:71], v[116:119], v[56:59]
    v_mfma_f32_16x16x32_bf16 v[60:63], v[68:71], v[120:123], v[60:63]
    v_mfma_f32_16x16x32_bf16 v[40:43], v[72:75], v[96:99], v[40:43]
    v_mfma_f32_16x16x32_bf16 v[44:47], v[72:75], v[100:103], v[44:47]
    v_mfma_f32_16x16x32_bf16 v[48:51], v[72:75], v[104:107], v[48:51]
    v_mfma_f32_16x16x32_bf16 v[52:55], v[72:75], v[108:111], v[52:55]
    v_mfma_f32_16x16x32_bf16 v[56:59], v[72:75], v[112:115], v[56:59]
    v_mfma_f32_16x16x32_bf16 v[60:63], v[72:75], v[116:119], v[60:63]
    s_barrier
    v_mfma_f32_16x16x32_bf16 v[44:47], v[76:79], v[96:99], v[44:47]
    v_mfma_f32_16x16x32_bf16 v[48:51], v[76:79], v[100:103], v[48:51]
    v_mfma_f32_16x16x32_bf16 v[52:55], v[76:79], v[104:107], v[52:55]
    v_mfma_f32_16x16x32_bf16 v[56:59], v[76:79], v[108:111], v[56:59]
    v_mfma_f32_16x16x32_bf16 v[60:63], v[76:79], v[112:115], v[60:63]
    v_mfma_f32_16x16x32_bf16 v[48:51], v[80:83], v[96:99], v[48:51]
    v_mfma_f32_16x16x32_bf16 v[52:55], v[80:83], v[100:103], v[52:55]
    v_mfma_f32_16x16x32_bf16 v[56:59], v[80:83], v[104:107], v[56:59]
    v_mfma_f32_16x16x32_bf16 v[60:63], v[80:83], v[108:111], v[60:63]
    v_mfma_f32_16x16x32_bf16 v[52:55], v[84:87], v[96:99], v[52:55]
    v_mfma_f32_16x16x32_bf16 v[56:59], v[84:87], v[100:103], v[56:59]
    v_mfma_f32_16x16x32_bf16 v[60:63], v[84:87], v[104:107], v[60:63]
    v_mfma_f32_16x16x32_bf16 v[56:59], v[88:91], v[96:99], v[56:59]
    v_mfma_f32_16x16x32_bf16 v[60:63], v[88:91], v[100:103], v[60:63]
    v_mfma_f32_16x16x32_bf16 v[60:63], v[92:95], v[96:99], v[60:63]
    ds_read2_b32 v[64:65], v24 offset0:96 offset1:97
    ds_read2_b32 v[66:67], v24 offset0:98 offset1:99
    ds_read_b128 v[96:99], v17 offset:64
    ds_read2_b32 v[68:69], v24 offset0:224 offset1:225
    ds_read2_b32 v[70:71], v24 offset0:226 offset1:227
    ds_read_b128 v[100:103], v17 offset:576
    ds_read2_b32 v[72:73], v25 offset0:96 offset1:97
    ds_read2_b32 v[74:75], v25 offset0:98 offset1:99
    ds_read_b128 v[104:107], v17 offset:1088
    ds_read2_b32 v[76:77], v25 offset0:224 offset1:225
    ds_read2_b32 v[78:79], v25 offset0:226 offset1:227
    ds_read_b128 v[108:111], v17 offset:1600
    s_barrier
    ds_read2_b32 v[80:81], v26 offset0:96 offset1:97
    ds_read2_b32 v[82:83], v26 offset0:98 offset1:99
    ds_read_b128 v[112:115], v17 offset:2112
    ds_read2_b32 v[84:85], v26 offset0:224 offset1:225
    ds_read2_b32 v[86:87], v26 offset0:226 offset1:227
    ds_read_b128 v[116:119], v17 offset:2624
    ds_read2_b32 v[88:89], v27 offset0:96 offset1:97
    ds_read2_b32 v[90:91], v27 offset0:98 offset1:99
    ds_read_b128 v[120:123], v17 offset:3136
    ds_read2_b32 v[92:93], v27 offset0:224 offset1:225
    ds_read2_b32 v[94:95], v27 offset0:226 offset1:227
    ds_read_b128 v[124:127], v17 offset:3648
    s_waitcnt lgkmcnt(0)
    v_mfma_f32_16x16x32_bf16 v[32:35], v[64:67], v[96:99], v[32:35]
    v_mfma_f32_16x16x32_bf16 v[36:39], v[64:67], v[100:103], v[36:39]
    v_mfma_f32_16x16x32_bf16 v[40:43], v[64:67], v[104:107], v[40:43]
    v_mfma_f32_16x16x32_bf16 v[44:47], v[64:67], v[108:111], v[44:47]
    v_mfma_f32_16x16x32_bf16 v[48:51], v[64:67], v[112:115], v[48:51]
    v_mfma_f32_16x16x32_bf16 v[52:55], v[64:67], v[116:119], v[52:55]
    v_mfma_f32_16x16x32_bf16 v[56:59], v[64:67], v[120:123], v[56:59]
    v_mfma_f32_16x16x32_bf16 v[60:63], v[64:67], v[124:127], v[60:63]
    v_mfma_f32_16x16x32_bf16 v[36:39], v[68:71], v[96:99], v[36:39]
    v_mfma_f32_16x16x32_bf16 v[40:43], v[68:71], v[100:103], v[40:43]
    v_mfma_f32_16x16x32_bf16 v[44:47], v[68:71], v[104:107], v[44:47]
    v_mfma_f32_16x16x32_bf16 v[48:51], v[68:71], v[108:111], v[48:51]
    v_mfma_f32_16x16x32_bf16 v[52:55], v[68:71], v[112:115], v[52:55]
    v_mfma_f32_16x16x32_bf16 v[56:59], v[68:71], v[116:119], v[56:59]
    s_barrier
    v_mfma_f32_16x16x32_bf16 v[60:63], v[68:71], v[120:123], v[60:63]
    v_mfma_f32_16x16x32_bf16 v[40:43], v[72:75], v[96:99], v[40:43]
    v_mfma_f32_16x16x32_bf16 v[44:47], v[72:75], v[100:103], v[44:47]
    v_mfma_f32_16x16x32_bf16 v[48:51], v[72:75], v[104:107], v[48:51]
    v_mfma_f32_16x16x32_bf16 v[52:55], v[72:75], v[108:111], v[52:55]
    v_mfma_f32_16x16x32_bf16 v[56:59], v[72:75], v[112:115], v[56:59]
    v_mfma_f32_16x16x32_bf16 v[60:63], v[72:75], v[116:119], v[60:63]
    v_mfma_f32_16x16x32_bf16 v[44:47], v[76:79], v[96:99], v[44:47]
    v_mfma_f32_16x16x32_bf16 v[48:51], v[76:79], v[100:103], v[48:51]
    v_mfma_f32_16x16x32_bf16 v[52:55], v[76:79], v[104:107], v[52:55]
    v_mfma_f32_16x16x32_bf16 v[56:59], v[76:79], v[108:111], v[56:59]
    v_mfma_f32_16x16x32_bf16 v[60:63], v[76:79], v[112:115], v[60:63]
    v_mfma_f32_16x16x32_bf16 v[48:51], v[80:83], v[96:99], v[48:51]
    v_mfma_f32_16x16x32_bf16 v[52:55], v[80:83], v[100:103], v[52:55]
    v_mfma_f32_16x16x32_bf16 v[56:59], v[80:83], v[104:107], v[56:59]
    v_mfma_f32_16x16x32_bf16 v[60:63], v[80:83], v[108:111], v[60:63]
    v_mfma_f32_16x16x32_bf16 v[52:55], v[84:87], v[96:99], v[52:55]
    v_mfma_f32_16x16x32_bf16 v[56:59], v[84:87], v[100:103], v[56:59]
    v_mfma_f32_16x16x32_bf16 v[60:63], v[84:87], v[104:107], v[60:63]
    v_mfma_f32_16x16x32_bf16 v[56:59], v[88:91], v[96:99], v[56:59]
    v_mfma_f32_16x16x32_bf16 v[60:63], v[88:91], v[100:103], v[60:63]
    v_mfma_f32_16x16x32_bf16 v[60:63], v[92:95], v[96:99], v[60:63]
    ds_read2_b32 v[64:65], v24 offset0:112 offset1:113
    ds_read2_b32 v[66:67], v24 offset0:114 offset1:115
    ds_read_b128 v[96:99], v17 offset:0
    ds_read2_b32 v[68:69], v24 offset0:240 offset1:241
    ds_read2_b32 v[70:71], v24 offset0:242 offset1:243
    s_barrier
    ds_read_b128 v[100:103], v17 offset:512
    ds_read2_b32 v[72:73], v25 offset0:112 offset1:113
    ds_read2_b32 v[74:75], v25 offset0:114 offset1:115
    ds_read_b128 v[104:107], v17 offset:1024
    ds_read2_b32 v[76:77], v25 offset0:240 offset1:241
    ds_read2_b32 v[78:79], v25 offset0:242 offset1:243
    ds_read_b128 v[108:111], v17 offset:1536
    ds_read2_b32 v[80:81], v26 offset0:112 offset1:113
    ds_read2_b32 v[82:83], v26 offset0:114 offset1:115
    ds_read_b128 v[112:115], v17 offset:2048
    ds_read2_b32 v[84:85], v26 offset0:240 offset1:241
    ds_read2_b32 v[86:87], v26 offset0:242 offset1:243
    ds_read_b128 v[116:119], v17 offset:2560
    ds_read2_b32 v[88:89], v27 offset0:112 offset1:113
    ds_read2_b32 v[90:91], v27 offset0:114 offset1:115
    ds_read_b128 v[120:123], v17 offset:3072
    ds_read2_b32 v[92:93], v27 offset0:240 offset1:241
    ds_read2_b32 v[94:95], v27 offset0:242 offset1:243
    ds_read_b128 v[124:127], v17 offset:3584
    s_waitcnt lgkmcnt(0)
    v_mfma_f32_16x16x32_bf16 v[32:35], v[64:67], v[96:99], v[32:35]
    v_mfma_f32_16x16x32_bf16 v[36:39], v[64:67], v[100:103], v[36:39]
    v_mfma_f32_16x16x32_bf16 v[40:43], v[64:67], v[104:107], v[40:43]
    v_mfma_f32_16x16x32_bf16 v[44:47], v[64:67], v[108:111], v[44:47]
    v_mfma_f32_16x16x32_bf16 v[48:51], v[64:67], v[112:115], v[48:51]
    v_mfma_f32_16x16x32_bf16 v[52:55], v[64:67], v[116:119], v[52:55]
    v_mfma_f32_16x16x32_bf16 v[56:59], v[64:67], v[120:123], v[56:59]
    s_barrier
    v_mfma_f32_16x16x32_bf16 v[60:63], v[64:67], v[124:127], v[60:63]
    v_mfma_f32_16x16x32_bf16 v[36:39], v[68:71], v[96:99], v[36:39]
    v_mfma_f32_16x16x32_bf16 v[40:43], v[68:71], v[100:103], v[40:43]
    v_mfma_f32_16x16x32_bf16 v[44:47], v[68:71], v[104:107], v[44:47]
    v_mfma_f32_16x16x32_bf16 v[48:51], v[68:71], v[108:111], v[48:51]
    v_mfma_f32_16x16x32_bf16 v[52:55], v[68:71], v[112:115], v[52:55]
    v_mfma_f32_16x16x32_bf16 v[56:59], v[68:71], v[116:119], v[56:59]
    v_mfma_f32_16x16x32_bf16 v[60:63], v[68:71], v[120:123], v[60:63]
    v_mfma_f32_16x16x32_bf16 v[40:43], v[72:75], v[96:99], v[40:43]
    v_mfma_f32_16x16x32_bf16 v[44:47], v[72:75], v[100:103], v[44:47]
    v_mfma_f32_16x16x32_bf16 v[48:51], v[72:75], v[104:107], v[48:51]
    v_mfma_f32_16x16x32_bf16 v[52:55], v[72:75], v[108:111], v[52:55]
    v_mfma_f32_16x16x32_bf16 v[56:59], v[72:75], v[112:115], v[56:59]
    v_mfma_f32_16x16x32_bf16 v[60:63], v[72:75], v[116:119], v[60:63]
    v_mfma_f32_16x16x32_bf16 v[44:47], v[76:79], v[96:99], v[44:47]
    v_mfma_f32_16x16x32_bf16 v[48:51], v[76:79], v[100:103], v[48:51]
    v_mfma_f32_16x16x32_bf16 v[52:55], v[76:79], v[104:107], v[52:55]
    v_mfma_f32_16x16x32_bf16 v[56:59], v[76:79], v[108:111], v[56:59]
    v_mfma_f32_16x16x32_bf16 v[60:63], v[76:79], v[112:115], v[60:63]
    v_mfma_f32_16x16x32_bf16 v[48:51], v[80:83], v[96:99], v[48:51]
    v_mfma_f32_16x16x32_bf16 v[52:55], v[80:83], v[100:103], v[52:55]
    v_mfma_f32_16x16x32_bf16 v[56:59], v[80:83], v[104:107], v[56:59]
    v_mfma_f32_16x16x32_bf16 v[60:63], v[80:83], v[108:111], v[60:63]
    v_mfma_f32_16x16x32_bf16 v[52:55], v[84:87], v[96:99], v[52:55]
    v_mfma_f32_16x16x32_bf16 v[56:59], v[84:87], v[100:103], v[56:59]
    v_mfma_f32_16x16x32_bf16 v[60:63], v[84:87], v[104:107], v[60:63]
    v_mfma_f32_16x16x32_bf16 v[56:59], v[88:91], v[96:99], v[56:59]
    s_barrier
    v_mfma_f32_16x16x32_bf16 v[60:63], v[88:91], v[100:103], v[60:63]
    v_mfma_f32_16x16x32_bf16 v[60:63], v[92:95], v[96:99], v[60:63]
    v_lshlrev_b32 v20, 16, v20
    ds_read_b64 v[64:65], v18 offset:0
    ds_read_b64 v[66:67], v18 offset:512
    ds_read_b64 v[68:69], v18 offset:1024
    ds_read_b64 v[70:71], v18 offset:1536
    ds_read_b64 v[72:73], v18 offset:2048
    ds_read_b64 v[74:75], v18 offset:2560
    ds_read_b64 v[76:77], v18 offset:3072
    ds_read_b64 v[78:79], v18 offset:3584
    s_nop 7
    s_waitcnt lgkmcnt(0)
    v_and_b32 v80, 0xffff0000, v65
    v_lshlrev_b32 v81, 16, v65
    v_and_b32 v82, 0xffff0000, v64
    v_lshlrev_b32 v83, 16, v64
    v_mul_f32 v80, v80, v20
    v_mul_f32 v81, v81, v20
    v_mul_f32 v82, v82, v20
    v_mul_f32 v83, v83, v20
    v_cvt_pk_bf16_f32 v84, v80, v81
    v_lshlrev_b32 v80, 16, v84
    v_and_b32 v81, 0xffff0000, v84
    v_cvt_pk_bf16_f32 v84, v82, v83
    v_lshlrev_b32 v82, 16, v84
    v_and_b32 v83, 0xffff0000, v84
    s_barrier
    v_cvt_pk_bf16_f32 v84, v32, v33
    v_lshlrev_b32 v32, 16, v84
    v_and_b32 v33, 0xffff0000, v84
    v_cvt_pk_bf16_f32 v84, v34, v35
    v_lshlrev_b32 v34, 16, v84
    v_and_b32 v35, 0xffff0000, v84
    v_add_f32 v32, v32, v80
    v_add_f32 v33, v33, v81
    v_add_f32 v34, v34, v82
    v_add_f32 v35, v35, v83
    v_cvt_pk_bf16_f32 v86, v32, v33
    v_cvt_pk_bf16_f32 v87, v34, v35
    buffer_store_dwordx2 v[86:87], v19, s[56:59], 0 offen offset:0
    v_and_b32 v80, 0xffff0000, v67
    v_lshlrev_b32 v81, 16, v67
    v_and_b32 v82, 0xffff0000, v66
    v_lshlrev_b32 v83, 16, v66
    v_mul_f32 v80, v80, v20
    v_mul_f32 v81, v81, v20
    v_mul_f32 v82, v82, v20
    v_mul_f32 v83, v83, v20
    v_cvt_pk_bf16_f32 v84, v80, v81
    v_lshlrev_b32 v80, 16, v84
    v_and_b32 v81, 0xffff0000, v84
    v_cvt_pk_bf16_f32 v84, v82, v83
    v_lshlrev_b32 v82, 16, v84
    v_and_b32 v83, 0xffff0000, v84
    s_barrier
    v_cvt_pk_bf16_f32 v84, v36, v37
    v_lshlrev_b32 v36, 16, v84
    v_and_b32 v37, 0xffff0000, v84
    v_cvt_pk_bf16_f32 v84, v38, v39
    v_lshlrev_b32 v38, 16, v84
    v_and_b32 v39, 0xffff0000, v84
    v_add_f32 v36, v36, v80
    v_add_f32 v37, v37, v81
    v_add_f32 v38, v38, v82
    v_add_f32 v39, v39, v83
    v_cvt_pk_bf16_f32 v88, v36, v37
    v_cvt_pk_bf16_f32 v89, v38, v39
    buffer_store_dwordx2 v[88:89], v19, s[56:59], 0 offen offset:512
    v_and_b32 v80, 0xffff0000, v69
    v_lshlrev_b32 v81, 16, v69
    v_and_b32 v82, 0xffff0000, v68
    v_lshlrev_b32 v83, 16, v68
    v_mul_f32 v80, v80, v20
    v_mul_f32 v81, v81, v20
    v_mul_f32 v82, v82, v20
    v_mul_f32 v83, v83, v20
    v_cvt_pk_bf16_f32 v84, v80, v81
    v_lshlrev_b32 v80, 16, v84
    v_and_b32 v81, 0xffff0000, v84
    v_cvt_pk_bf16_f32 v84, v82, v83
    v_lshlrev_b32 v82, 16, v84
    v_and_b32 v83, 0xffff0000, v84
    s_barrier
    v_cvt_pk_bf16_f32 v84, v40, v41
    v_lshlrev_b32 v40, 16, v84
    v_and_b32 v41, 0xffff0000, v84
    v_cvt_pk_bf16_f32 v84, v42, v43
    v_lshlrev_b32 v42, 16, v84
    v_and_b32 v43, 0xffff0000, v84
    v_add_f32 v40, v40, v80
    v_add_f32 v41, v41, v81
    v_add_f32 v42, v42, v82
    v_add_f32 v43, v43, v83
    v_cvt_pk_bf16_f32 v86, v40, v41
    v_cvt_pk_bf16_f32 v87, v42, v43
    buffer_store_dwordx2 v[86:87], v19, s[56:59], 0 offen offset:1024
    v_and_b32 v80, 0xffff0000, v71
    v_lshlrev_b32 v81, 16, v71
    v_and_b32 v82, 0xffff0000, v70
    v_lshlrev_b32 v83, 16, v70
    v_mul_f32 v80, v80, v20
    v_mul_f32 v81, v81, v20
    v_mul_f32 v82, v82, v20
    v_mul_f32 v83, v83, v20
    v_cvt_pk_bf16_f32 v84, v80, v81
    v_lshlrev_b32 v80, 16, v84
    v_and_b32 v81, 0xffff0000, v84
    v_cvt_pk_bf16_f32 v84, v82, v83
    v_lshlrev_b32 v82, 16, v84
    v_and_b32 v83, 0xffff0000, v84
    s_barrier
    v_cvt_pk_bf16_f32 v84, v44, v45
    v_lshlrev_b32 v44, 16, v84
    v_and_b32 v45, 0xffff0000, v84
    v_cvt_pk_bf16_f32 v84, v46, v47
    v_lshlrev_b32 v46, 16, v84
    v_and_b32 v47, 0xffff0000, v84
    v_add_f32 v44, v44, v80
    v_add_f32 v45, v45, v81
    v_add_f32 v46, v46, v82
    v_add_f32 v47, v47, v83
    v_cvt_pk_bf16_f32 v88, v44, v45
    v_cvt_pk_bf16_f32 v89, v46, v47
    buffer_store_dwordx2 v[88:89], v19, s[56:59], 0 offen offset:1536
    v_and_b32 v80, 0xffff0000, v73
    v_lshlrev_b32 v81, 16, v73
    v_and_b32 v82, 0xffff0000, v72
    v_lshlrev_b32 v83, 16, v72
    v_mul_f32 v80, v80, v20
    v_mul_f32 v81, v81, v20
    v_mul_f32 v82, v82, v20
    v_mul_f32 v83, v83, v20
    v_cvt_pk_bf16_f32 v84, v80, v81
    v_lshlrev_b32 v80, 16, v84
    v_and_b32 v81, 0xffff0000, v84
    v_cvt_pk_bf16_f32 v84, v82, v83
    v_lshlrev_b32 v82, 16, v84
    v_and_b32 v83, 0xffff0000, v84
    s_barrier
    v_cvt_pk_bf16_f32 v84, v48, v49
    v_lshlrev_b32 v48, 16, v84
    v_and_b32 v49, 0xffff0000, v84
    v_cvt_pk_bf16_f32 v84, v50, v51
    v_lshlrev_b32 v50, 16, v84
    v_and_b32 v51, 0xffff0000, v84
    v_add_f32 v48, v48, v80
    v_add_f32 v49, v49, v81
    v_add_f32 v50, v50, v82
    v_add_f32 v51, v51, v83
    v_cvt_pk_bf16_f32 v86, v48, v49
    v_cvt_pk_bf16_f32 v87, v50, v51
    buffer_store_dwordx2 v[86:87], v19, s[56:59], 0 offen offset:2048
    v_and_b32 v80, 0xffff0000, v75
    v_lshlrev_b32 v81, 16, v75
    v_and_b32 v82, 0xffff0000, v74
    v_lshlrev_b32 v83, 16, v74
    v_mul_f32 v80, v80, v20
    v_mul_f32 v81, v81, v20
    v_mul_f32 v82, v82, v20
    v_mul_f32 v83, v83, v20
    v_cvt_pk_bf16_f32 v84, v80, v81
    v_lshlrev_b32 v80, 16, v84
    v_and_b32 v81, 0xffff0000, v84
    v_cvt_pk_bf16_f32 v84, v82, v83
    v_lshlrev_b32 v82, 16, v84
    v_and_b32 v83, 0xffff0000, v84
    s_barrier
    v_cvt_pk_bf16_f32 v84, v52, v53
    v_lshlrev_b32 v52, 16, v84
    v_and_b32 v53, 0xffff0000, v84
    v_cvt_pk_bf16_f32 v84, v54, v55
    v_lshlrev_b32 v54, 16, v84
    v_and_b32 v55, 0xffff0000, v84
    v_add_f32 v52, v52, v80
    v_add_f32 v53, v53, v81
    v_add_f32 v54, v54, v82
    v_add_f32 v55, v55, v83
    v_cvt_pk_bf16_f32 v88, v52, v53
    v_cvt_pk_bf16_f32 v89, v54, v55
    buffer_store_dwordx2 v[88:89], v19, s[56:59], 0 offen offset:2560
    v_and_b32 v80, 0xffff0000, v77
    v_lshlrev_b32 v81, 16, v77
    v_and_b32 v82, 0xffff0000, v76
    v_lshlrev_b32 v83, 16, v76
    v_mul_f32 v80, v80, v20
    v_mul_f32 v81, v81, v20
    v_mul_f32 v82, v82, v20
    v_mul_f32 v83, v83, v20
    v_cvt_pk_bf16_f32 v84, v80, v81
    v_lshlrev_b32 v80, 16, v84
    v_and_b32 v81, 0xffff0000, v84
    v_cvt_pk_bf16_f32 v84, v82, v83
    v_lshlrev_b32 v82, 16, v84
    v_and_b32 v83, 0xffff0000, v84
    s_barrier
    v_cvt_pk_bf16_f32 v84, v56, v57
    v_lshlrev_b32 v56, 16, v84
    v_and_b32 v57, 0xffff0000, v84
    v_cvt_pk_bf16_f32 v84, v58, v59
    v_lshlrev_b32 v58, 16, v84
    v_and_b32 v59, 0xffff0000, v84
    v_add_f32 v56, v56, v80
    v_add_f32 v57, v57, v81
    v_add_f32 v58, v58, v82
    v_add_f32 v59, v59, v83
    v_cvt_pk_bf16_f32 v86, v56, v57
    v_cvt_pk_bf16_f32 v87, v58, v59
    buffer_store_dwordx2 v[86:87], v19, s[56:59], 0 offen offset:3072
    v_and_b32 v80, 0xffff0000, v79
    v_lshlrev_b32 v81, 16, v79
    v_and_b32 v82, 0xffff0000, v78
    v_lshlrev_b32 v83, 16, v78
    v_mul_f32 v80, v80, v20
    v_mul_f32 v81, v81, v20
    v_mul_f32 v82, v82, v20
    v_mul_f32 v83, v83, v20
    v_cvt_pk_bf16_f32 v84, v80, v81
    v_lshlrev_b32 v80, 16, v84
    v_and_b32 v81, 0xffff0000, v84
    v_cvt_pk_bf16_f32 v84, v82, v83
    v_lshlrev_b32 v82, 16, v84
    v_and_b32 v83, 0xffff0000, v84
    s_barrier
    v_cvt_pk_bf16_f32 v84, v60, v61
    v_lshlrev_b32 v60, 16, v84
    v_and_b32 v61, 0xffff0000, v84
    v_cvt_pk_bf16_f32 v84, v62, v63
    v_lshlrev_b32 v62, 16, v84
    v_and_b32 v63, 0xffff0000, v84
    v_add_f32 v60, v60, v80
    v_add_f32 v61, v61, v81
    v_add_f32 v62, v62, v82
    v_add_f32 v63, v63, v83
    v_cvt_pk_bf16_f32 v88, v60, v61
    v_cvt_pk_bf16_f32 v89, v62, v63
    buffer_store_dwordx2 v[88:89], v19, s[56:59], 0 offen offset:3584
    s_endpgm
g1_convx:
    s_sub_u32 s16, s16, 8
    s_lshl_b32 s64, s2, 2
    s_add_u32 s64, s64, s16
    s_lshl_b32 s65, s64, 12
    s_add_u32 s48, s68, s65
    s_addc_u32 s49, s69, 0
    s_movk_i32 s50, 4096
    s_mov_b32 s51, 0x00020000
    s_add_u32 s52, s8, s65
    s_addc_u32 s53, s9, 0
    s_add_u32 s56, s52, 12582912
    s_addc_u32 s57, s53, 0
    s_movk_i32 s58, 4096
    s_mov_b32 s59, 0x00020000
    s_add_u32 s52, s52, 8388608
    s_addc_u32 s53, s53, 0
    s_movk_i32 s54, 4096
    s_mov_b32 s55, 0x00020000
    s_mov_b32 s60, s70
    s_mov_b32 s61, s71
    s_mov_b32 s62, 2048
    s_mov_b32 s63, 0x00020000
    s_mul_i32 s66, s16, 12928
    s_add_u32 s66, s66, 98304
    v_lshlrev_b32 v21, 4, v1
    s_add_u32 m0, s66, 480
    s_nop 0
    buffer_load_dwordx4 v21, s[52:55], 0 offen offset:0 lds
    buffer_load_dwordx4 v21, s[52:55], 0 offen offset:1024 lds
    buffer_load_dwordx4 v21, s[52:55], 0 offen offset:2048 lds
    buffer_load_dwordx4 v21, s[52:55], 0 offen offset:3072 lds
    v_lshlrev_b32 v22, 6, v1
    v_subrev_u32 v22, 32, v22
    v_add_u32 v23, 0, v22
    buffer_load_dwordx4 v[64:67], v23, s[48:51], 0 offen
    v_add_u32 v23, 16, v22
    buffer_load_dwordx4 v[68:71], v23, s[48:51], 0 offen
    v_add_u32 v23, 32, v22
    buffer_load_dwordx4 v[72:75], v23, s[48:51], 0 offen
    v_add_u32 v23, 48, v22
    buffer_load_dwordx4 v[76:79], v23, s[48:51], 0 offen
    v_add_u32 v23, 64, v22
    buffer_load_dword v80, v23, s[48:51], 0 offen
    v_mov_b32 v23, 4064
    buffer_load_dwordx4 v[84:87], v23, s[48:51], 0 offen
    buffer_load_dwordx4 v[88:91], v23, s[48:51], 0 offen offset:16
    v_mov_b32 v92, 0
    s_lshl_b32 s65, s64, 1
    v_mov_b32 v22, s65
    buffer_load_ushort v20, v22, s[60:63], 0 offen
    v_mov_b32 v32, 0
    v_mov_b32 v33, 0
    v_mov_b32 v34, 0
    v_mov_b32 v35, 0
    v_add_u32 v22, s66, v21
    v_cmp_gt_u32 vcc, 30, v1
    s_and_saveexec_b64 s[72:73], vcc
    ds_write_b128 v22, v[32:35]
    s_mov_b64 exec, s[72:73]
    v_and_b32 v22, 15, v1
    v_lshrrev_b32 v23, 4, v1
    v_add_u32 v16, 1, v22
    v_and_b32 v16, 1, v16
    v_lshlrev_b32 v17, 3, v23
    v_sub_u32 v17, v22, v17
    v_sub_u32 v17, v17, v16
    v_lshlrev_b32 v17, 1, v17
    v_mul_u32_u24 v16, 4160, v16
    v_add_u32 v16, v16, v17
    v_add_u32 v16, s66, v16
    v_add_u32 v24, 4658, v16
    v_add_u32 v25, 5682, v16
    v_add_u32 v26, 6706, v16
    v_add_u32 v27, 7730, v16
    v_lshlrev_b32 v17, 5, v22
    v_lshl_add_u32 v17, v23, 4, v17
    v_add_u32 v17, s66, v17
    v_and_b32 v18, 1, v23
    v_lshlrev_b32 v18, 3, v18
    v_lshrrev_b32 v19, 1, v23
    v_lshlrev_b32 v19, 4, v19
    v_lshl_add_u32 v19, v22, 5, v19
    v_sub_u32 v18, v19, v18
    v_add_u32 v18, s66, v18
    v_add_u32 v18, 488, v18
    v_lshlrev_b32 v19, 5, v22
    v_lshl_add_u32 v19, v23, 3, v19
    s_waitcnt vmcnt(0)
    v_mov_b32 v32, 0
    v_mov_b32 v33, 0
    v_mov_b32 v34, 0
    v_mov_b32 v35, 0
    v_mov_b32 v36, 0
    v_mov_b32 v37, 0
    v_mov_b32 v38, 0
    v_mov_b32 v39, 0
    v_mov_b32 v40, 0
    v_mov_b32 v41, 0
    v_mov_b32 v42, 0
    v_mov_b32 v43, 0
    v_mov_b32 v44, 0
    v_mov_b32 v45, 0
    v_mov_b32 v46, 0
    v_mov_b32 v47, 0
    v_mov_b32 v48, 0
    v_mov_b32 v49, 0
    v_mov_b32 v50, 0
    v_mov_b32 v51, 0
    v_mov_b32 v52, 0
    v_mov_b32 v53, 0
    v_mov_b32 v54, 0
    v_mov_b32 v55, 0
    v_mov_b32 v56, 0
    v_mov_b32 v57, 0
    v_mov_b32 v58, 0
    v_mov_b32 v59, 0
    v_mov_b32 v60, 0
    v_mov_b32 v61, 0
    v_mov_b32 v62, 0
    v_mov_b32 v63, 0
    v_lshlrev_b32 v21, 6, v1
    v_add_u32 v21, s66, v21
    v_alignbit_b32 v96, v65, v64, 16
    v_alignbit_b32 v97, v66, v65, 16
    v_alignbit_b32 v98, v67, v66, 16
    v_alignbit_b32 v99, v68, v67, 16
    v_alignbit_b32 v100, v69, v68, 16
    v_alignbit_b32 v101, v70, v69, 16
    v_alignbit_b32 v102, v71, v70, 16
    v_alignbit_b32 v103, v72, v71, 16
    v_alignbit_b32 v104, v73, v72, 16
    v_alignbit_b32 v105, v74, v73, 16
    v_alignbit_b32 v106, v75, v74, 16
    v_alignbit_b32 v107, v76, v75, 16
    v_alignbit_b32 v108, v77, v76, 16
    v_alignbit_b32 v109, v78, v77, 16
    v_alignbit_b32 v110, v79, v78, 16
    v_alignbit_b32 v111, v80, v79, 16
    ds_write_b128 v21, v[64:67] offset:4608
    ds_write_b128 v21, v[96:99] offset:8768
    ds_write_b128 v21, v[68:71] offset:4624
    ds_write_b128 v21, v[100:103] offset:8784
    ds_write_b128 v21, v[72:75] offset:4640
    ds_write_b128 v21, v[104:107] offset:8800
    ds_write_b128 v21, v[76:79] offset:4656
    ds_write_b128 v21, v[108:111] offset:8816
    v_alignbit_b32 v112, v85, v84, 16
    v_alignbit_b32 v113, v86, v85, 16
    v_alignbit_b32 v114, v87, v86, 16
    v_alignbit_b32 v115, v88, v87, 16
    v_alignbit_b32 v116, v89, v88, 16
    v_alignbit_b32 v117, v90, v89, 16
    v_alignbit_b32 v118, v91, v90, 16
    v_alignbit_b32 v119, v92, v91, 16
    v_cmp_eq_u32 vcc, 0, v1
    s_and_saveexec_b64 s[72:73], vcc
    ds_write_b128 v21, v[84:87] offset:8704
    ds_write_b128 v21, v[112:115] offset:12864
    ds_write_b128 v21, v[88:91] offset:8720
    ds_write_b128 v21, v[116:119] offset:12880
    s_mov_b64 exec, s[72:73]
    s_waitcnt lgkmcnt(0)
    ds_read2_b32 v[64:65], v24 offset0:0 offset1:1
    ds_read2_b32 v[66:67], v24 offset0:2 offset1:3
    ds_read_b128 v[96:99], v17 offset:448
    ds_read2_b32 v[68:69], v24 offset0:128 offset1:129
    ds_read2_b32 v[70:71], v24 offset0:130 offset1:131
    ds_read_b128 v[100:103], v17 offset:960
    ds_read2_b32 v[72:73], v25 offset0:0 offset1:1
    ds_read2_b32 v[74:75], v25 offset0:2 offset1:3
    ds_read_b128 v[104:107], v17 offset:1472
    ds_read2_b32 v[76:77], v25 offset0:128 offset1:129
    ds_read2_b32 v[78:79], v25 offset0:130 offset1:131
    ds_read_b128 v[108:111], v17 offset:1984
    ds_read2_b32 v[80:81], v26 offset0:0 offset1:1
    ds_read2_b32 v[82:83], v26 offset0:2 offset1:3
    ds_read_b128 v[112:115], v17 offset:2496
    ds_read2_b32 v[84:85], v26 offset0:128 offset1:129
    ds_read2_b32 v[86:87], v26 offset0:130 offset1:131
    ds_read_b128 v[116:119], v17 offset:3008
    ds_read2_b32 v[88:89], v27 offset0:0 offset1:1
    ds_read2_b32 v[90:91], v27 offset0:2 offset1:3
    ds_read_b128 v[120:123], v17 offset:3520
    ds_read2_b32 v[92:93], v27 offset0:128 offset1:129
    ds_read2_b32 v[94:95], v27 offset0:130 offset1:131
    ds_read_b128 v[124:127], v17 offset:4032
    s_waitcnt lgkmcnt(0)
    v_mfma_f32_16x16x32_bf16 v[32:35], v[64:67], v[96:99], v[32:35]
    v_mfma_f32_16x16x32_bf16 v[36:39], v[64:67], v[100:103], v[36:39]
    v_mfma_f32_16x16x32_bf16 v[40:43], v[64:67], v[104:107], v[40:43]
    v_mfma_f32_16x16x32_bf16 v[44:47], v[64:67], v[108:111], v[44:47]
    v_mfma_f32_16x16x32_bf16 v[48:51], v[64:67], v[112:115], v[48:51]
    v_mfma_f32_16x16x32_bf16 v[52:55], v[64:67], v[116:119], v[52:55]
    v_mfma_f32_16x16x32_bf16 v[56:59], v[64:67], v[120:123], v[56:59]
    v_mfma_f32_16x16x32_bf16 v[60:63], v[64:67], v[124:127], v[60:63]
    v_mfma_f32_16x16x32_bf16 v[36:39], v[68:71], v[96:99], v[36:39]
    v_mfma_f32_16x16x32_bf16 v[40:43], v[68:71], v[100:103], v[40:43]
    v_mfma_f32_16x16x32_bf16 v[44:47], v[68:71], v[104:107], v[44:47]
    v_mfma_f32_16x16x32_bf16 v[48:51], v[68:71], v[108:111], v[48:51]
    v_mfma_f32_16x16x32_bf16 v[52:55], v[68:71], v[112:115], v[52:55]
    v_mfma_f32_16x16x32_bf16 v[56:59], v[68:71], v[116:119], v[56:59]
    v_mfma_f32_16x16x32_bf16 v[60:63], v[68:71], v[120:123], v[60:63]
    v_mfma_f32_16x16x32_bf16 v[40:43], v[72:75], v[96:99], v[40:43]
    v_mfma_f32_16x16x32_bf16 v[44:47], v[72:75], v[100:103], v[44:47]
    v_mfma_f32_16x16x32_bf16 v[48:51], v[72:75], v[104:107], v[48:51]
    v_mfma_f32_16x16x32_bf16 v[52:55], v[72:75], v[108:111], v[52:55]
    v_mfma_f32_16x16x32_bf16 v[56:59], v[72:75], v[112:115], v[56:59]
    v_mfma_f32_16x16x32_bf16 v[60:63], v[72:75], v[116:119], v[60:63]
    v_mfma_f32_16x16x32_bf16 v[44:47], v[76:79], v[96:99], v[44:47]
    v_mfma_f32_16x16x32_bf16 v[48:51], v[76:79], v[100:103], v[48:51]
    v_mfma_f32_16x16x32_bf16 v[52:55], v[76:79], v[104:107], v[52:55]
    v_mfma_f32_16x16x32_bf16 v[56:59], v[76:79], v[108:111], v[56:59]
    v_mfma_f32_16x16x32_bf16 v[60:63], v[76:79], v[112:115], v[60:63]
    v_mfma_f32_16x16x32_bf16 v[48:51], v[80:83], v[96:99], v[48:51]
    v_mfma_f32_16x16x32_bf16 v[52:55], v[80:83], v[100:103], v[52:55]
    v_mfma_f32_16x16x32_bf16 v[56:59], v[80:83], v[104:107], v[56:59]
    v_mfma_f32_16x16x32_bf16 v[60:63], v[80:83], v[108:111], v[60:63]
    v_mfma_f32_16x16x32_bf16 v[52:55], v[84:87], v[96:99], v[52:55]
    v_mfma_f32_16x16x32_bf16 v[56:59], v[84:87], v[100:103], v[56:59]
    v_mfma_f32_16x16x32_bf16 v[60:63], v[84:87], v[104:107], v[60:63]
    v_mfma_f32_16x16x32_bf16 v[56:59], v[88:91], v[96:99], v[56:59]
    v_mfma_f32_16x16x32_bf16 v[60:63], v[88:91], v[100:103], v[60:63]
    v_mfma_f32_16x16x32_bf16 v[60:63], v[92:95], v[96:99], v[60:63]
    ds_read2_b32 v[64:65], v24 offset0:16 offset1:17
    ds_read2_b32 v[66:67], v24 offset0:18 offset1:19
    ds_read_b128 v[96:99], v17 offset:384
    ds_read2_b32 v[68:69], v24 offset0:144 offset1:145
    ds_read2_b32 v[70:71], v24 offset0:146 offset1:147
    ds_read_b128 v[100:103], v17 offset:896
    ds_read2_b32 v[72:73], v25 offset0:16 offset1:17
    ds_read2_b32 v[74:75], v25 offset0:18 offset1:19
    ds_read_b128 v[104:107], v17 offset:1408
    ds_read2_b32 v[76:77], v25 offset0:144 offset1:145
    ds_read2_b32 v[78:79], v25 offset0:146 offset1:147
    ds_read_b128 v[108:111], v17 offset:1920
    ds_read2_b32 v[80:81], v26 offset0:16 offset1:17
    ds_read2_b32 v[82:83], v26 offset0:18 offset1:19
    ds_read_b128 v[112:115], v17 offset:2432
    ds_read2_b32 v[84:85], v26 offset0:144 offset1:145
    ds_read2_b32 v[86:87], v26 offset0:146 offset1:147
    ds_read_b128 v[116:119], v17 offset:2944
    ds_read2_b32 v[88:89], v27 offset0:16 offset1:17
    ds_read2_b32 v[90:91], v27 offset0:18 offset1:19
    ds_read_b128 v[120:123], v17 offset:3456
    ds_read2_b32 v[92:93], v27 offset0:144 offset1:145
    ds_read2_b32 v[94:95], v27 offset0:146 offset1:147
    ds_read_b128 v[124:127], v17 offset:3968
    s_waitcnt lgkmcnt(0)
    v_mfma_f32_16x16x32_bf16 v[32:35], v[64:67], v[96:99], v[32:35]
    v_mfma_f32_16x16x32_bf16 v[36:39], v[64:67], v[100:103], v[36:39]
    v_mfma_f32_16x16x32_bf16 v[40:43], v[64:67], v[104:107], v[40:43]
    v_mfma_f32_16x16x32_bf16 v[44:47], v[64:67], v[108:111], v[44:47]
    v_mfma_f32_16x16x32_bf16 v[48:51], v[64:67], v[112:115], v[48:51]
    v_mfma_f32_16x16x32_bf16 v[52:55], v[64:67], v[116:119], v[52:55]
    v_mfma_f32_16x16x32_bf16 v[56:59], v[64:67], v[120:123], v[56:59]
    v_mfma_f32_16x16x32_bf16 v[60:63], v[64:67], v[124:127], v[60:63]
    v_mfma_f32_16x16x32_bf16 v[36:39], v[68:71], v[96:99], v[36:39]
    v_mfma_f32_16x16x32_bf16 v[40:43], v[68:71], v[100:103], v[40:43]
    v_mfma_f32_16x16x32_bf16 v[44:47], v[68:71], v[104:107], v[44:47]
    v_mfma_f32_16x16x32_bf16 v[48:51], v[68:71], v[108:111], v[48:51]
    v_mfma_f32_16x16x32_bf16 v[52:55], v[68:71], v[112:115], v[52:55]
    v_mfma_f32_16x16x32_bf16 v[56:59], v[68:71], v[116:119], v[56:59]
    v_mfma_f32_16x16x32_bf16 v[60:63], v[68:71], v[120:123], v[60:63]
    v_mfma_f32_16x16x32_bf16 v[40:43], v[72:75], v[96:99], v[40:43]
    v_mfma_f32_16x16x32_bf16 v[44:47], v[72:75], v[100:103], v[44:47]
    v_mfma_f32_16x16x32_bf16 v[48:51], v[72:75], v[104:107], v[48:51]
    v_mfma_f32_16x16x32_bf16 v[52:55], v[72:75], v[108:111], v[52:55]
    v_mfma_f32_16x16x32_bf16 v[56:59], v[72:75], v[112:115], v[56:59]
    v_mfma_f32_16x16x32_bf16 v[60:63], v[72:75], v[116:119], v[60:63]
    v_mfma_f32_16x16x32_bf16 v[44:47], v[76:79], v[96:99], v[44:47]
    v_mfma_f32_16x16x32_bf16 v[48:51], v[76:79], v[100:103], v[48:51]
    v_mfma_f32_16x16x32_bf16 v[52:55], v[76:79], v[104:107], v[52:55]
    v_mfma_f32_16x16x32_bf16 v[56:59], v[76:79], v[108:111], v[56:59]
    v_mfma_f32_16x16x32_bf16 v[60:63], v[76:79], v[112:115], v[60:63]
    v_mfma_f32_16x16x32_bf16 v[48:51], v[80:83], v[96:99], v[48:51]
    v_mfma_f32_16x16x32_bf16 v[52:55], v[80:83], v[100:103], v[52:55]
    v_mfma_f32_16x16x32_bf16 v[56:59], v[80:83], v[104:107], v[56:59]
    v_mfma_f32_16x16x32_bf16 v[60:63], v[80:83], v[108:111], v[60:63]
    v_mfma_f32_16x16x32_bf16 v[52:55], v[84:87], v[96:99], v[52:55]
    v_mfma_f32_16x16x32_bf16 v[56:59], v[84:87], v[100:103], v[56:59]
    v_mfma_f32_16x16x32_bf16 v[60:63], v[84:87], v[104:107], v[60:63]
    v_mfma_f32_16x16x32_bf16 v[56:59], v[88:91], v[96:99], v[56:59]
    v_mfma_f32_16x16x32_bf16 v[60:63], v[88:91], v[100:103], v[60:63]
    v_mfma_f32_16x16x32_bf16 v[60:63], v[92:95], v[96:99], v[60:63]
    ds_read2_b32 v[64:65], v24 offset0:32 offset1:33
    ds_read2_b32 v[66:67], v24 offset0:34 offset1:35
    ds_read_b128 v[96:99], v17 offset:320
    ds_read2_b32 v[68:69], v24 offset0:160 offset1:161
    ds_read2_b32 v[70:71], v24 offset0:162 offset1:163
    ds_read_b128 v[100:103], v17 offset:832
    ds_read2_b32 v[72:73], v25 offset0:32 offset1:33
    ds_read2_b32 v[74:75], v25 offset0:34 offset1:35
    ds_read_b128 v[104:107], v17 offset:1344
    ds_read2_b32 v[76:77], v25 offset0:160 offset1:161
    ds_read2_b32 v[78:79], v25 offset0:162 offset1:163
    ds_read_b128 v[108:111], v17 offset:1856
    ds_read2_b32 v[80:81], v26 offset0:32 offset1:33
    ds_read2_b32 v[82:83], v26 offset0:34 offset1:35
    ds_read_b128 v[112:115], v17 offset:2368
    ds_read2_b32 v[84:85], v26 offset0:160 offset1:161
    ds_read2_b32 v[86:87], v26 offset0:162 offset1:163
    ds_read_b128 v[116:119], v17 offset:2880
    ds_read2_b32 v[88:89], v27 offset0:32 offset1:33
    ds_read2_b32 v[90:91], v27 offset0:34 offset1:35
    ds_read_b128 v[120:123], v17 offset:3392
    ds_read2_b32 v[92:93], v27 offset0:160 offset1:161
    ds_read2_b32 v[94:95], v27 offset0:162 offset1:163
    ds_read_b128 v[124:127], v17 offset:3904
    s_waitcnt lgkmcnt(0)
    v_mfma_f32_16x16x32_bf16 v[32:35], v[64:67], v[96:99], v[32:35]
    v_mfma_f32_16x16x32_bf16 v[36:39], v[64:67], v[100:103], v[36:39]
    v_mfma_f32_16x16x32_bf16 v[40:43], v[64:67], v[104:107], v[40:43]
    v_mfma_f32_16x16x32_bf16 v[44:47], v[64:67], v[108:111], v[44:47]
    v_mfma_f32_16x16x32_bf16 v[48:51], v[64:67], v[112:115], v[48:51]
    v_mfma_f32_16x16x32_bf16 v[52:55], v[64:67], v[116:119], v[52:55]
    v_mfma_f32_16x16x32_bf16 v[56:59], v[64:67], v[120:123], v[56:59]
    v_mfma_f32_16x16x32_bf16 v[60:63], v[64:67], v[124:127], v[60:63]
    v_mfma_f32_16x16x32_bf16 v[36:39], v[68:71], v[96:99], v[36:39]
    v_mfma_f32_16x16x32_bf16 v[40:43], v[68:71], v[100:103], v[40:43]
    v_mfma_f32_16x16x32_bf16 v[44:47], v[68:71], v[104:107], v[44:47]
    v_mfma_f32_16x16x32_bf16 v[48:51], v[68:71], v[108:111], v[48:51]
    v_mfma_f32_16x16x32_bf16 v[52:55], v[68:71], v[112:115], v[52:55]
    v_mfma_f32_16x16x32_bf16 v[56:59], v[68:71], v[116:119], v[56:59]
    v_mfma_f32_16x16x32_bf16 v[60:63], v[68:71], v[120:123], v[60:63]
    v_mfma_f32_16x16x32_bf16 v[40:43], v[72:75], v[96:99], v[40:43]
    v_mfma_f32_16x16x32_bf16 v[44:47], v[72:75], v[100:103], v[44:47]
    v_mfma_f32_16x16x32_bf16 v[48:51], v[72:75], v[104:107], v[48:51]
    v_mfma_f32_16x16x32_bf16 v[52:55], v[72:75], v[108:111], v[52:55]
    v_mfma_f32_16x16x32_bf16 v[56:59], v[72:75], v[112:115], v[56:59]
    v_mfma_f32_16x16x32_bf16 v[60:63], v[72:75], v[116:119], v[60:63]
    v_mfma_f32_16x16x32_bf16 v[44:47], v[76:79], v[96:99], v[44:47]
    v_mfma_f32_16x16x32_bf16 v[48:51], v[76:79], v[100:103], v[48:51]
    v_mfma_f32_16x16x32_bf16 v[52:55], v[76:79], v[104:107], v[52:55]
    v_mfma_f32_16x16x32_bf16 v[56:59], v[76:79], v[108:111], v[56:59]
    v_mfma_f32_16x16x32_bf16 v[60:63], v[76:79], v[112:115], v[60:63]
    v_mfma_f32_16x16x32_bf16 v[48:51], v[80:83], v[96:99], v[48:51]
    v_mfma_f32_16x16x32_bf16 v[52:55], v[80:83], v[100:103], v[52:55]
    v_mfma_f32_16x16x32_bf16 v[56:59], v[80:83], v[104:107], v[56:59]
    v_mfma_f32_16x16x32_bf16 v[60:63], v[80:83], v[108:111], v[60:63]
    v_mfma_f32_16x16x32_bf16 v[52:55], v[84:87], v[96:99], v[52:55]
    v_mfma_f32_16x16x32_bf16 v[56:59], v[84:87], v[100:103], v[56:59]
    v_mfma_f32_16x16x32_bf16 v[60:63], v[84:87], v[104:107], v[60:63]
    v_mfma_f32_16x16x32_bf16 v[56:59], v[88:91], v[96:99], v[56:59]
    v_mfma_f32_16x16x32_bf16 v[60:63], v[88:91], v[100:103], v[60:63]
    v_mfma_f32_16x16x32_bf16 v[60:63], v[92:95], v[96:99], v[60:63]
    ds_read2_b32 v[64:65], v24 offset0:48 offset1:49
    ds_read2_b32 v[66:67], v24 offset0:50 offset1:51
    ds_read_b128 v[96:99], v17 offset:256
    ds_read2_b32 v[68:69], v24 offset0:176 offset1:177
    ds_read2_b32 v[70:71], v24 offset0:178 offset1:179
    ds_read_b128 v[100:103], v17 offset:768
    ds_read2_b32 v[72:73], v25 offset0:48 offset1:49
    ds_read2_b32 v[74:75], v25 offset0:50 offset1:51
    ds_read_b128 v[104:107], v17 offset:1280
    ds_read2_b32 v[76:77], v25 offset0:176 offset1:177
    ds_read2_b32 v[78:79], v25 offset0:178 offset1:179
    ds_read_b128 v[108:111], v17 offset:1792
    ds_read2_b32 v[80:81], v26 offset0:48 offset1:49
    ds_read2_b32 v[82:83], v26 offset0:50 offset1:51
    ds_read_b128 v[112:115], v17 offset:2304
    ds_read2_b32 v[84:85], v26 offset0:176 offset1:177
    ds_read2_b32 v[86:87], v26 offset0:178 offset1:179
    ds_read_b128 v[116:119], v17 offset:2816
    ds_read2_b32 v[88:89], v27 offset0:48 offset1:49
    ds_read2_b32 v[90:91], v27 offset0:50 offset1:51
    ds_read_b128 v[120:123], v17 offset:3328
    ds_read2_b32 v[92:93], v27 offset0:176 offset1:177
    ds_read2_b32 v[94:95], v27 offset0:178 offset1:179
    ds_read_b128 v[124:127], v17 offset:3840
    s_waitcnt lgkmcnt(0)
    v_mfma_f32_16x16x32_bf16 v[32:35], v[64:67], v[96:99], v[32:35]
    v_mfma_f32_16x16x32_bf16 v[36:39], v[64:67], v[100:103], v[36:39]
    v_mfma_f32_16x16x32_bf16 v[40:43], v[64:67], v[104:107], v[40:43]
    v_mfma_f32_16x16x32_bf16 v[44:47], v[64:67], v[108:111], v[44:47]
    v_mfma_f32_16x16x32_bf16 v[48:51], v[64:67], v[112:115], v[48:51]
    v_mfma_f32_16x16x32_bf16 v[52:55], v[64:67], v[116:119], v[52:55]
    v_mfma_f32_16x16x32_bf16 v[56:59], v[64:67], v[120:123], v[56:59]
    v_mfma_f32_16x16x32_bf16 v[60:63], v[64:67], v[124:127], v[60:63]
    v_mfma_f32_16x16x32_bf16 v[36:39], v[68:71], v[96:99], v[36:39]
    v_mfma_f32_16x16x32_bf16 v[40:43], v[68:71], v[100:103], v[40:43]
    v_mfma_f32_16x16x32_bf16 v[44:47], v[68:71], v[104:107], v[44:47]
    v_mfma_f32_16x16x32_bf16 v[48:51], v[68:71], v[108:111], v[48:51]
    v_mfma_f32_16x16x32_bf16 v[52:55], v[68:71], v[112:115], v[52:55]
    v_mfma_f32_16x16x32_bf16 v[56:59], v[68:71], v[116:119], v[56:59]
    v_mfma_f32_16x16x32_bf16 v[60:63], v[68:71], v[120:123], v[60:63]
    v_mfma_f32_16x16x32_bf16 v[40:43], v[72:75], v[96:99], v[40:43]
    v_mfma_f32_16x16x32_bf16 v[44:47], v[72:75], v[100:103], v[44:47]
    v_mfma_f32_16x16x32_bf16 v[48:51], v[72:75], v[104:107], v[48:51]
    v_mfma_f32_16x16x32_bf16 v[52:55], v[72:75], v[108:111], v[52:55]
    v_mfma_f32_16x16x32_bf16 v[56:59], v[72:75], v[112:115], v[56:59]
    v_mfma_f32_16x16x32_bf16 v[60:63], v[72:75], v[116:119], v[60:63]
    v_mfma_f32_16x16x32_bf16 v[44:47], v[76:79], v[96:99], v[44:47]
    v_mfma_f32_16x16x32_bf16 v[48:51], v[76:79], v[100:103], v[48:51]
    v_mfma_f32_16x16x32_bf16 v[52:55], v[76:79], v[104:107], v[52:55]
    v_mfma_f32_16x16x32_bf16 v[56:59], v[76:79], v[108:111], v[56:59]
    v_mfma_f32_16x16x32_bf16 v[60:63], v[76:79], v[112:115], v[60:63]
    v_mfma_f32_16x16x32_bf16 v[48:51], v[80:83], v[96:99], v[48:51]
    v_mfma_f32_16x16x32_bf16 v[52:55], v[80:83], v[100:103], v[52:55]
    v_mfma_f32_16x16x32_bf16 v[56:59], v[80:83], v[104:107], v[56:59]
    v_mfma_f32_16x16x32_bf16 v[60:63], v[80:83], v[108:111], v[60:63]
    v_mfma_f32_16x16x32_bf16 v[52:55], v[84:87], v[96:99], v[52:55]
    v_mfma_f32_16x16x32_bf16 v[56:59], v[84:87], v[100:103], v[56:59]
    v_mfma_f32_16x16x32_bf16 v[60:63], v[84:87], v[104:107], v[60:63]
    v_mfma_f32_16x16x32_bf16 v[56:59], v[88:91], v[96:99], v[56:59]
    v_mfma_f32_16x16x32_bf16 v[60:63], v[88:91], v[100:103], v[60:63]
    v_mfma_f32_16x16x32_bf16 v[60:63], v[92:95], v[96:99], v[60:63]
    ds_read2_b32 v[64:65], v24 offset0:64 offset1:65
    ds_read2_b32 v[66:67], v24 offset0:66 offset1:67
    ds_read_b128 v[96:99], v17 offset:192
    ds_read2_b32 v[68:69], v24 offset0:192 offset1:193
    ds_read2_b32 v[70:71], v24 offset0:194 offset1:195
    ds_read_b128 v[100:103], v17 offset:704
    ds_read2_b32 v[72:73], v25 offset0:64 offset1:65
    ds_read2_b32 v[74:75], v25 offset0:66 offset1:67
    ds_read_b128 v[104:107], v17 offset:1216
    ds_read2_b32 v[76:77], v25 offset0:192 offset1:193
    ds_read2_b32 v[78:79], v25 offset0:194 offset1:195
    ds_read_b128 v[108:111], v17 offset:1728
    ds_read2_b32 v[80:81], v26 offset0:64 offset1:65
    ds_read2_b32 v[82:83], v26 offset0:66 offset1:67
    ds_read_b128 v[112:115], v17 offset:2240
    ds_read2_b32 v[84:85], v26 offset0:192 offset1:193
    ds_read2_b32 v[86:87], v26 offset0:194 offset1:195
    ds_read_b128 v[116:119], v17 offset:2752
    ds_read2_b32 v[88:89], v27 offset0:64 offset1:65
    ds_read2_b32 v[90:91], v27 offset0:66 offset1:67
    ds_read_b128 v[120:123], v17 offset:3264
    ds_read2_b32 v[92:93], v27 offset0:192 offset1:193
    ds_read2_b32 v[94:95], v27 offset0:194 offset1:195
    ds_read_b128 v[124:127], v17 offset:3776
    s_waitcnt lgkmcnt(0)
    v_mfma_f32_16x16x32_bf16 v[32:35], v[64:67], v[96:99], v[32:35]
    v_mfma_f32_16x16x32_bf16 v[36:39], v[64:67], v[100:103], v[36:39]
    v_mfma_f32_16x16x32_bf16 v[40:43], v[64:67], v[104:107], v[40:43]
    v_mfma_f32_16x16x32_bf16 v[44:47], v[64:67], v[108:111], v[44:47]
    v_mfma_f32_16x16x32_bf16 v[48:51], v[64:67], v[112:115], v[48:51]
    v_mfma_f32_16x16x32_bf16 v[52:55], v[64:67], v[116:119], v[52:55]
    v_mfma_f32_16x16x32_bf16 v[56:59], v[64:67], v[120:123], v[56:59]
    v_mfma_f32_16x16x32_bf16 v[60:63], v[64:67], v[124:127], v[60:63]
    v_mfma_f32_16x16x32_bf16 v[36:39], v[68:71], v[96:99], v[36:39]
    v_mfma_f32_16x16x32_bf16 v[40:43], v[68:71], v[100:103], v[40:43]
    v_mfma_f32_16x16x32_bf16 v[44:47], v[68:71], v[104:107], v[44:47]
    v_mfma_f32_16x16x32_bf16 v[48:51], v[68:71], v[108:111], v[48:51]
    v_mfma_f32_16x16x32_bf16 v[52:55], v[68:71], v[112:115], v[52:55]
    v_mfma_f32_16x16x32_bf16 v[56:59], v[68:71], v[116:119], v[56:59]
    v_mfma_f32_16x16x32_bf16 v[60:63], v[68:71], v[120:123], v[60:63]
    v_mfma_f32_16x16x32_bf16 v[40:43], v[72:75], v[96:99], v[40:43]
    v_mfma_f32_16x16x32_bf16 v[44:47], v[72:75], v[100:103], v[44:47]
    v_mfma_f32_16x16x32_bf16 v[48:51], v[72:75], v[104:107], v[48:51]
    v_mfma_f32_16x16x32_bf16 v[52:55], v[72:75], v[108:111], v[52:55]
    v_mfma_f32_16x16x32_bf16 v[56:59], v[72:75], v[112:115], v[56:59]
    v_mfma_f32_16x16x32_bf16 v[60:63], v[72:75], v[116:119], v[60:63]
    v_mfma_f32_16x16x32_bf16 v[44:47], v[76:79], v[96:99], v[44:47]
    v_mfma_f32_16x16x32_bf16 v[48:51], v[76:79], v[100:103], v[48:51]
    v_mfma_f32_16x16x32_bf16 v[52:55], v[76:79], v[104:107], v[52:55]
    v_mfma_f32_16x16x32_bf16 v[56:59], v[76:79], v[108:111], v[56:59]
    v_mfma_f32_16x16x32_bf16 v[60:63], v[76:79], v[112:115], v[60:63]
    v_mfma_f32_16x16x32_bf16 v[48:51], v[80:83], v[96:99], v[48:51]
    v_mfma_f32_16x16x32_bf16 v[52:55], v[80:83], v[100:103], v[52:55]
    v_mfma_f32_16x16x32_bf16 v[56:59], v[80:83], v[104:107], v[56:59]
    v_mfma_f32_16x16x32_bf16 v[60:63], v[80:83], v[108:111], v[60:63]
    v_mfma_f32_16x16x32_bf16 v[52:55], v[84:87], v[96:99], v[52:55]
    v_mfma_f32_16x16x32_bf16 v[56:59], v[84:87], v[100:103], v[56:59]
    v_mfma_f32_16x16x32_bf16 v[60:63], v[84:87], v[104:107], v[60:63]
    v_mfma_f32_16x16x32_bf16 v[56:59], v[88:91], v[96:99], v[56:59]
    v_mfma_f32_16x16x32_bf16 v[60:63], v[88:91], v[100:103], v[60:63]
    v_mfma_f32_16x16x32_bf16 v[60:63], v[92:95], v[96:99], v[60:63]
    ds_read2_b32 v[64:65], v24 offset0:80 offset1:81
    ds_read2_b32 v[66:67], v24 offset0:82 offset1:83
    ds_read_b128 v[96:99], v17 offset:128
    ds_read2_b32 v[68:69], v24 offset0:208 offset1:209
    ds_read2_b32 v[70:71], v24 offset0:210 offset1:211
    ds_read_b128 v[100:103], v17 offset:640
    ds_read2_b32 v[72:73], v25 offset0:80 offset1:81
    ds_read2_b32 v[74:75], v25 offset0:82 offset1:83
    ds_read_b128 v[104:107], v17 offset:1152
    ds_read2_b32 v[76:77], v25 offset0:208 offset1:209
    ds_read2_b32 v[78:79], v25 offset0:210 offset1:211
    ds_read_b128 v[108:111], v17 offset:1664
    ds_read2_b32 v[80:81], v26 offset0:80 offset1:81
    ds_read2_b32 v[82:83], v26 offset0:82 offset1:83
    ds_read_b128 v[112:115], v17 offset:2176
    ds_read2_b32 v[84:85], v26 offset0:208 offset1:209
    ds_read2_b32 v[86:87], v26 offset0:210 offset1:211
    ds_read_b128 v[116:119], v17 offset:2688
    ds_read2_b32 v[88:89], v27 offset0:80 offset1:81
    ds_read2_b32 v[90:91], v27 offset0:82 offset1:83
    ds_read_b128 v[120:123], v17 offset:3200
    ds_read2_b32 v[92:93], v27 offset0:208 offset1:209
    ds_read2_b32 v[94:95], v27 offset0:210 offset1:211
    ds_read_b128 v[124:127], v17 offset:3712
    s_waitcnt lgkmcnt(0)
    v_mfma_f32_16x16x32_bf16 v[32:35], v[64:67], v[96:99], v[32:35]
    v_mfma_f32_16x16x32_bf16 v[36:39], v[64:67], v[100:103], v[36:39]
    v_mfma_f32_16x16x32_bf16 v[40:43], v[64:67], v[104:107], v[40:43]
    v_mfma_f32_16x16x32_bf16 v[44:47], v[64:67], v[108:111], v[44:47]
    v_mfma_f32_16x16x32_bf16 v[48:51], v[64:67], v[112:115], v[48:51]
    v_mfma_f32_16x16x32_bf16 v[52:55], v[64:67], v[116:119], v[52:55]
    v_mfma_f32_16x16x32_bf16 v[56:59], v[64:67], v[120:123], v[56:59]
    v_mfma_f32_16x16x32_bf16 v[60:63], v[64:67], v[124:127], v[60:63]
    v_mfma_f32_16x16x32_bf16 v[36:39], v[68:71], v[96:99], v[36:39]
    v_mfma_f32_16x16x32_bf16 v[40:43], v[68:71], v[100:103], v[40:43]
    v_mfma_f32_16x16x32_bf16 v[44:47], v[68:71], v[104:107], v[44:47]
    v_mfma_f32_16x16x32_bf16 v[48:51], v[68:71], v[108:111], v[48:51]
    v_mfma_f32_16x16x32_bf16 v[52:55], v[68:71], v[112:115], v[52:55]
    v_mfma_f32_16x16x32_bf16 v[56:59], v[68:71], v[116:119], v[56:59]
    v_mfma_f32_16x16x32_bf16 v[60:63], v[68:71], v[120:123], v[60:63]
    v_mfma_f32_16x16x32_bf16 v[40:43], v[72:75], v[96:99], v[40:43]
    v_mfma_f32_16x16x32_bf16 v[44:47], v[72:75], v[100:103], v[44:47]
    v_mfma_f32_16x16x32_bf16 v[48:51], v[72:75], v[104:107], v[48:51]
    v_mfma_f32_16x16x32_bf16 v[52:55], v[72:75], v[108:111], v[52:55]
    v_mfma_f32_16x16x32_bf16 v[56:59], v[72:75], v[112:115], v[56:59]
    v_mfma_f32_16x16x32_bf16 v[60:63], v[72:75], v[116:119], v[60:63]
    v_mfma_f32_16x16x32_bf16 v[44:47], v[76:79], v[96:99], v[44:47]
    v_mfma_f32_16x16x32_bf16 v[48:51], v[76:79], v[100:103], v[48:51]
    v_mfma_f32_16x16x32_bf16 v[52:55], v[76:79], v[104:107], v[52:55]
    v_mfma_f32_16x16x32_bf16 v[56:59], v[76:79], v[108:111], v[56:59]
    v_mfma_f32_16x16x32_bf16 v[60:63], v[76:79], v[112:115], v[60:63]
    v_mfma_f32_16x16x32_bf16 v[48:51], v[80:83], v[96:99], v[48:51]
    v_mfma_f32_16x16x32_bf16 v[52:55], v[80:83], v[100:103], v[52:55]
    v_mfma_f32_16x16x32_bf16 v[56:59], v[80:83], v[104:107], v[56:59]
    v_mfma_f32_16x16x32_bf16 v[60:63], v[80:83], v[108:111], v[60:63]
    v_mfma_f32_16x16x32_bf16 v[52:55], v[84:87], v[96:99], v[52:55]
    v_mfma_f32_16x16x32_bf16 v[56:59], v[84:87], v[100:103], v[56:59]
    v_mfma_f32_16x16x32_bf16 v[60:63], v[84:87], v[104:107], v[60:63]
    v_mfma_f32_16x16x32_bf16 v[56:59], v[88:91], v[96:99], v[56:59]
    v_mfma_f32_16x16x32_bf16 v[60:63], v[88:91], v[100:103], v[60:63]
    v_mfma_f32_16x16x32_bf16 v[60:63], v[92:95], v[96:99], v[60:63]
    ds_read2_b32 v[64:65], v24 offset0:96 offset1:97
    ds_read2_b32 v[66:67], v24 offset0:98 offset1:99
    ds_read_b128 v[96:99], v17 offset:64
    ds_read2_b32 v[68:69], v24 offset0:224 offset1:225
    ds_read2_b32 v[70:71], v24 offset0:226 offset1:227
    ds_read_b128 v[100:103], v17 offset:576
    ds_read2_b32 v[72:73], v25 offset0:96 offset1:97
    ds_read2_b32 v[74:75], v25 offset0:98 offset1:99
    ds_read_b128 v[104:107], v17 offset:1088
    ds_read2_b32 v[76:77], v25 offset0:224 offset1:225
    ds_read2_b32 v[78:79], v25 offset0:226 offset1:227
    ds_read_b128 v[108:111], v17 offset:1600
    ds_read2_b32 v[80:81], v26 offset0:96 offset1:97
    ds_read2_b32 v[82:83], v26 offset0:98 offset1:99
    ds_read_b128 v[112:115], v17 offset:2112
    ds_read2_b32 v[84:85], v26 offset0:224 offset1:225
    ds_read2_b32 v[86:87], v26 offset0:226 offset1:227
    ds_read_b128 v[116:119], v17 offset:2624
    ds_read2_b32 v[88:89], v27 offset0:96 offset1:97
    ds_read2_b32 v[90:91], v27 offset0:98 offset1:99
    ds_read_b128 v[120:123], v17 offset:3136
    ds_read2_b32 v[92:93], v27 offset0:224 offset1:225
    ds_read2_b32 v[94:95], v27 offset0:226 offset1:227
    ds_read_b128 v[124:127], v17 offset:3648
    s_waitcnt lgkmcnt(0)
    v_mfma_f32_16x16x32_bf16 v[32:35], v[64:67], v[96:99], v[32:35]
    v_mfma_f32_16x16x32_bf16 v[36:39], v[64:67], v[100:103], v[36:39]
    v_mfma_f32_16x16x32_bf16 v[40:43], v[64:67], v[104:107], v[40:43]
    v_mfma_f32_16x16x32_bf16 v[44:47], v[64:67], v[108:111], v[44:47]
    v_mfma_f32_16x16x32_bf16 v[48:51], v[64:67], v[112:115], v[48:51]
    v_mfma_f32_16x16x32_bf16 v[52:55], v[64:67], v[116:119], v[52:55]
    v_mfma_f32_16x16x32_bf16 v[56:59], v[64:67], v[120:123], v[56:59]
    v_mfma_f32_16x16x32_bf16 v[60:63], v[64:67], v[124:127], v[60:63]
    v_mfma_f32_16x16x32_bf16 v[36:39], v[68:71], v[96:99], v[36:39]
    v_mfma_f32_16x16x32_bf16 v[40:43], v[68:71], v[100:103], v[40:43]
    v_mfma_f32_16x16x32_bf16 v[44:47], v[68:71], v[104:107], v[44:47]
    v_mfma_f32_16x16x32_bf16 v[48:51], v[68:71], v[108:111], v[48:51]
    v_mfma_f32_16x16x32_bf16 v[52:55], v[68:71], v[112:115], v[52:55]
    v_mfma_f32_16x16x32_bf16 v[56:59], v[68:71], v[116:119], v[56:59]
    v_mfma_f32_16x16x32_bf16 v[60:63], v[68:71], v[120:123], v[60:63]
    v_mfma_f32_16x16x32_bf16 v[40:43], v[72:75], v[96:99], v[40:43]
    v_mfma_f32_16x16x32_bf16 v[44:47], v[72:75], v[100:103], v[44:47]
    v_mfma_f32_16x16x32_bf16 v[48:51], v[72:75], v[104:107], v[48:51]
    v_mfma_f32_16x16x32_bf16 v[52:55], v[72:75], v[108:111], v[52:55]
    v_mfma_f32_16x16x32_bf16 v[56:59], v[72:75], v[112:115], v[56:59]
    v_mfma_f32_16x16x32_bf16 v[60:63], v[72:75], v[116:119], v[60:63]
    v_mfma_f32_16x16x32_bf16 v[44:47], v[76:79], v[96:99], v[44:47]
    v_mfma_f32_16x16x32_bf16 v[48:51], v[76:79], v[100:103], v[48:51]
    v_mfma_f32_16x16x32_bf16 v[52:55], v[76:79], v[104:107], v[52:55]
    v_mfma_f32_16x16x32_bf16 v[56:59], v[76:79], v[108:111], v[56:59]
    v_mfma_f32_16x16x32_bf16 v[60:63], v[76:79], v[112:115], v[60:63]
    v_mfma_f32_16x16x32_bf16 v[48:51], v[80:83], v[96:99], v[48:51]
    v_mfma_f32_16x16x32_bf16 v[52:55], v[80:83], v[100:103], v[52:55]
    v_mfma_f32_16x16x32_bf16 v[56:59], v[80:83], v[104:107], v[56:59]
    v_mfma_f32_16x16x32_bf16 v[60:63], v[80:83], v[108:111], v[60:63]
    v_mfma_f32_16x16x32_bf16 v[52:55], v[84:87], v[96:99], v[52:55]
    v_mfma_f32_16x16x32_bf16 v[56:59], v[84:87], v[100:103], v[56:59]
    v_mfma_f32_16x16x32_bf16 v[60:63], v[84:87], v[104:107], v[60:63]
    v_mfma_f32_16x16x32_bf16 v[56:59], v[88:91], v[96:99], v[56:59]
    v_mfma_f32_16x16x32_bf16 v[60:63], v[88:91], v[100:103], v[60:63]
    v_mfma_f32_16x16x32_bf16 v[60:63], v[92:95], v[96:99], v[60:63]
    ds_read2_b32 v[64:65], v24 offset0:112 offset1:113
    ds_read2_b32 v[66:67], v24 offset0:114 offset1:115
    ds_read_b128 v[96:99], v17 offset:0
    ds_read2_b32 v[68:69], v24 offset0:240 offset1:241
    ds_read2_b32 v[70:71], v24 offset0:242 offset1:243
    ds_read_b128 v[100:103], v17 offset:512
    ds_read2_b32 v[72:73], v25 offset0:112 offset1:113
    ds_read2_b32 v[74:75], v25 offset0:114 offset1:115
    ds_read_b128 v[104:107], v17 offset:1024
    ds_read2_b32 v[76:77], v25 offset0:240 offset1:241
    ds_read2_b32 v[78:79], v25 offset0:242 offset1:243
    ds_read_b128 v[108:111], v17 offset:1536
    ds_read2_b32 v[80:81], v26 offset0:112 offset1:113
    ds_read2_b32 v[82:83], v26 offset0:114 offset1:115
    ds_read_b128 v[112:115], v17 offset:2048
    ds_read2_b32 v[84:85], v26 offset0:240 offset1:241
    ds_read2_b32 v[86:87], v26 offset0:242 offset1:243
    ds_read_b128 v[116:119], v17 offset:2560
    ds_read2_b32 v[88:89], v27 offset0:112 offset1:113
    ds_read2_b32 v[90:91], v27 offset0:114 offset1:115
    ds_read_b128 v[120:123], v17 offset:3072
    ds_read2_b32 v[92:93], v27 offset0:240 offset1:241
    ds_read2_b32 v[94:95], v27 offset0:242 offset1:243
    ds_read_b128 v[124:127], v17 offset:3584
    s_waitcnt lgkmcnt(0)
    v_mfma_f32_16x16x32_bf16 v[32:35], v[64:67], v[96:99], v[32:35]
    v_mfma_f32_16x16x32_bf16 v[36:39], v[64:67], v[100:103], v[36:39]
    v_mfma_f32_16x16x32_bf16 v[40:43], v[64:67], v[104:107], v[40:43]
    v_mfma_f32_16x16x32_bf16 v[44:47], v[64:67], v[108:111], v[44:47]
    v_mfma_f32_16x16x32_bf16 v[48:51], v[64:67], v[112:115], v[48:51]
    v_mfma_f32_16x16x32_bf16 v[52:55], v[64:67], v[116:119], v[52:55]
    v_mfma_f32_16x16x32_bf16 v[56:59], v[64:67], v[120:123], v[56:59]
    v_mfma_f32_16x16x32_bf16 v[60:63], v[64:67], v[124:127], v[60:63]
    v_mfma_f32_16x16x32_bf16 v[36:39], v[68:71], v[96:99], v[36:39]
    v_mfma_f32_16x16x32_bf16 v[40:43], v[68:71], v[100:103], v[40:43]
    v_mfma_f32_16x16x32_bf16 v[44:47], v[68:71], v[104:107], v[44:47]
    v_mfma_f32_16x16x32_bf16 v[48:51], v[68:71], v[108:111], v[48:51]
    v_mfma_f32_16x16x32_bf16 v[52:55], v[68:71], v[112:115], v[52:55]
    v_mfma_f32_16x16x32_bf16 v[56:59], v[68:71], v[116:119], v[56:59]
    v_mfma_f32_16x16x32_bf16 v[60:63], v[68:71], v[120:123], v[60:63]
    v_mfma_f32_16x16x32_bf16 v[40:43], v[72:75], v[96:99], v[40:43]
    v_mfma_f32_16x16x32_bf16 v[44:47], v[72:75], v[100:103], v[44:47]
    v_mfma_f32_16x16x32_bf16 v[48:51], v[72:75], v[104:107], v[48:51]
    v_mfma_f32_16x16x32_bf16 v[52:55], v[72:75], v[108:111], v[52:55]
    v_mfma_f32_16x16x32_bf16 v[56:59], v[72:75], v[112:115], v[56:59]
    v_mfma_f32_16x16x32_bf16 v[60:63], v[72:75], v[116:119], v[60:63]
    v_mfma_f32_16x16x32_bf16 v[44:47], v[76:79], v[96:99], v[44:47]
    v_mfma_f32_16x16x32_bf16 v[48:51], v[76:79], v[100:103], v[48:51]
    v_mfma_f32_16x16x32_bf16 v[52:55], v[76:79], v[104:107], v[52:55]
    v_mfma_f32_16x16x32_bf16 v[56:59], v[76:79], v[108:111], v[56:59]
    v_mfma_f32_16x16x32_bf16 v[60:63], v[76:79], v[112:115], v[60:63]
    v_mfma_f32_16x16x32_bf16 v[48:51], v[80:83], v[96:99], v[48:51]
    v_mfma_f32_16x16x32_bf16 v[52:55], v[80:83], v[100:103], v[52:55]
    v_mfma_f32_16x16x32_bf16 v[56:59], v[80:83], v[104:107], v[56:59]
    v_mfma_f32_16x16x32_bf16 v[60:63], v[80:83], v[108:111], v[60:63]
    v_mfma_f32_16x16x32_bf16 v[52:55], v[84:87], v[96:99], v[52:55]
    v_mfma_f32_16x16x32_bf16 v[56:59], v[84:87], v[100:103], v[56:59]
    v_mfma_f32_16x16x32_bf16 v[60:63], v[84:87], v[104:107], v[60:63]
    v_mfma_f32_16x16x32_bf16 v[56:59], v[88:91], v[96:99], v[56:59]
    v_mfma_f32_16x16x32_bf16 v[60:63], v[88:91], v[100:103], v[60:63]
    v_mfma_f32_16x16x32_bf16 v[60:63], v[92:95], v[96:99], v[60:63]
    v_lshlrev_b32 v20, 16, v20
    ds_read_b64 v[64:65], v18 offset:0
    ds_read_b64 v[66:67], v18 offset:512
    ds_read_b64 v[68:69], v18 offset:1024
    ds_read_b64 v[70:71], v18 offset:1536
    ds_read_b64 v[72:73], v18 offset:2048
    ds_read_b64 v[74:75], v18 offset:2560
    ds_read_b64 v[76:77], v18 offset:3072
    ds_read_b64 v[78:79], v18 offset:3584
    s_nop 7
    s_waitcnt lgkmcnt(0)
    v_and_b32 v80, 0xffff0000, v65
    v_lshlrev_b32 v81, 16, v65
    v_and_b32 v82, 0xffff0000, v64
    v_lshlrev_b32 v83, 16, v64
    v_mul_f32 v80, v80, v20
    v_mul_f32 v81, v81, v20
    v_mul_f32 v82, v82, v20
    v_mul_f32 v83, v83, v20
    v_cvt_pk_bf16_f32 v84, v80, v81
    v_lshlrev_b32 v80, 16, v84
    v_and_b32 v81, 0xffff0000, v84
    v_cvt_pk_bf16_f32 v84, v82, v83
    v_lshlrev_b32 v82, 16, v84
    v_and_b32 v83, 0xffff0000, v84
    v_cvt_pk_bf16_f32 v84, v32, v33
    v_lshlrev_b32 v32, 16, v84
    v_and_b32 v33, 0xffff0000, v84
    v_cvt_pk_bf16_f32 v84, v34, v35
    v_lshlrev_b32 v34, 16, v84
    v_and_b32 v35, 0xffff0000, v84
    v_add_f32 v32, v32, v80
    v_add_f32 v33, v33, v81
    v_add_f32 v34, v34, v82
    v_add_f32 v35, v35, v83
    v_cvt_pk_bf16_f32 v86, v32, v33
    v_cvt_pk_bf16_f32 v87, v34, v35
    buffer_store_dwordx2 v[86:87], v19, s[56:59], 0 offen offset:0
    v_and_b32 v80, 0xffff0000, v67
    v_lshlrev_b32 v81, 16, v67
    v_and_b32 v82, 0xffff0000, v66
    v_lshlrev_b32 v83, 16, v66
    v_mul_f32 v80, v80, v20
    v_mul_f32 v81, v81, v20
    v_mul_f32 v82, v82, v20
    v_mul_f32 v83, v83, v20
    v_cvt_pk_bf16_f32 v84, v80, v81
    v_lshlrev_b32 v80, 16, v84
    v_and_b32 v81, 0xffff0000, v84
    v_cvt_pk_bf16_f32 v84, v82, v83
    v_lshlrev_b32 v82, 16, v84
    v_and_b32 v83, 0xffff0000, v84
    v_cvt_pk_bf16_f32 v84, v36, v37
    v_lshlrev_b32 v36, 16, v84
    v_and_b32 v37, 0xffff0000, v84
    v_cvt_pk_bf16_f32 v84, v38, v39
    v_lshlrev_b32 v38, 16, v84
    v_and_b32 v39, 0xffff0000, v84
    v_add_f32 v36, v36, v80
    v_add_f32 v37, v37, v81
    v_add_f32 v38, v38, v82
    v_add_f32 v39, v39, v83
    v_cvt_pk_bf16_f32 v88, v36, v37
    v_cvt_pk_bf16_f32 v89, v38, v39
    buffer_store_dwordx2 v[88:89], v19, s[56:59], 0 offen offset:512
    v_and_b32 v80, 0xffff0000, v69
    v_lshlrev_b32 v81, 16, v69
    v_and_b32 v82, 0xffff0000, v68
    v_lshlrev_b32 v83, 16, v68
    v_mul_f32 v80, v80, v20
    v_mul_f32 v81, v81, v20
    v_mul_f32 v82, v82, v20
    v_mul_f32 v83, v83, v20
    v_cvt_pk_bf16_f32 v84, v80, v81
    v_lshlrev_b32 v80, 16, v84
    v_and_b32 v81, 0xffff0000, v84
    v_cvt_pk_bf16_f32 v84, v82, v83
    v_lshlrev_b32 v82, 16, v84
    v_and_b32 v83, 0xffff0000, v84
    v_cvt_pk_bf16_f32 v84, v40, v41
    v_lshlrev_b32 v40, 16, v84
    v_and_b32 v41, 0xffff0000, v84
    v_cvt_pk_bf16_f32 v84, v42, v43
    v_lshlrev_b32 v42, 16, v84
    v_and_b32 v43, 0xffff0000, v84
    v_add_f32 v40, v40, v80
    v_add_f32 v41, v41, v81
    v_add_f32 v42, v42, v82
    v_add_f32 v43, v43, v83
    v_cvt_pk_bf16_f32 v86, v40, v41
    v_cvt_pk_bf16_f32 v87, v42, v43
    buffer_store_dwordx2 v[86:87], v19, s[56:59], 0 offen offset:1024
    v_and_b32 v80, 0xffff0000, v71
    v_lshlrev_b32 v81, 16, v71
    v_and_b32 v82, 0xffff0000, v70
    v_lshlrev_b32 v83, 16, v70
    v_mul_f32 v80, v80, v20
    v_mul_f32 v81, v81, v20
    v_mul_f32 v82, v82, v20
    v_mul_f32 v83, v83, v20
    v_cvt_pk_bf16_f32 v84, v80, v81
    v_lshlrev_b32 v80, 16, v84
    v_and_b32 v81, 0xffff0000, v84
    v_cvt_pk_bf16_f32 v84, v82, v83
    v_lshlrev_b32 v82, 16, v84
    v_and_b32 v83, 0xffff0000, v84
    v_cvt_pk_bf16_f32 v84, v44, v45
    v_lshlrev_b32 v44, 16, v84
    v_and_b32 v45, 0xffff0000, v84
    v_cvt_pk_bf16_f32 v84, v46, v47
    v_lshlrev_b32 v46, 16, v84
    v_and_b32 v47, 0xffff0000, v84
    v_add_f32 v44, v44, v80
    v_add_f32 v45, v45, v81
    v_add_f32 v46, v46, v82
    v_add_f32 v47, v47, v83
    v_cvt_pk_bf16_f32 v88, v44, v45
    v_cvt_pk_bf16_f32 v89, v46, v47
    buffer_store_dwordx2 v[88:89], v19, s[56:59], 0 offen offset:1536
    v_and_b32 v80, 0xffff0000, v73
    v_lshlrev_b32 v81, 16, v73
    v_and_b32 v82, 0xffff0000, v72
    v_lshlrev_b32 v83, 16, v72
    v_mul_f32 v80, v80, v20
    v_mul_f32 v81, v81, v20
    v_mul_f32 v82, v82, v20
    v_mul_f32 v83, v83, v20
    v_cvt_pk_bf16_f32 v84, v80, v81
    v_lshlrev_b32 v80, 16, v84
    v_and_b32 v81, 0xffff0000, v84
    v_cvt_pk_bf16_f32 v84, v82, v83
    v_lshlrev_b32 v82, 16, v84
    v_and_b32 v83, 0xffff0000, v84
    v_cvt_pk_bf16_f32 v84, v48, v49
    v_lshlrev_b32 v48, 16, v84
    v_and_b32 v49, 0xffff0000, v84
    v_cvt_pk_bf16_f32 v84, v50, v51
    v_lshlrev_b32 v50, 16, v84
    v_and_b32 v51, 0xffff0000, v84
    v_add_f32 v48, v48, v80
    v_add_f32 v49, v49, v81
    v_add_f32 v50, v50, v82
    v_add_f32 v51, v51, v83
    v_cvt_pk_bf16_f32 v86, v48, v49
    v_cvt_pk_bf16_f32 v87, v50, v51
    buffer_store_dwordx2 v[86:87], v19, s[56:59], 0 offen offset:2048
    v_and_b32 v80, 0xffff0000, v75
    v_lshlrev_b32 v81, 16, v75
    v_and_b32 v82, 0xffff0000, v74
    v_lshlrev_b32 v83, 16, v74
    v_mul_f32 v80, v80, v20
    v_mul_f32 v81, v81, v20
    v_mul_f32 v82, v82, v20
    v_mul_f32 v83, v83, v20
    v_cvt_pk_bf16_f32 v84, v80, v81
    v_lshlrev_b32 v80, 16, v84
    v_and_b32 v81, 0xffff0000, v84
    v_cvt_pk_bf16_f32 v84, v82, v83
    v_lshlrev_b32 v82, 16, v84
    v_and_b32 v83, 0xffff0000, v84
    v_cvt_pk_bf16_f32 v84, v52, v53
    v_lshlrev_b32 v52, 16, v84
    v_and_b32 v53, 0xffff0000, v84
    v_cvt_pk_bf16_f32 v84, v54, v55
    v_lshlrev_b32 v54, 16, v84
    v_and_b32 v55, 0xffff0000, v84
    v_add_f32 v52, v52, v80
    v_add_f32 v53, v53, v81
    v_add_f32 v54, v54, v82
    v_add_f32 v55, v55, v83
    v_cvt_pk_bf16_f32 v88, v52, v53
    v_cvt_pk_bf16_f32 v89, v54, v55
    buffer_store_dwordx2 v[88:89], v19, s[56:59], 0 offen offset:2560
    v_and_b32 v80, 0xffff0000, v77
    v_lshlrev_b32 v81, 16, v77
    v_and_b32 v82, 0xffff0000, v76
    v_lshlrev_b32 v83, 16, v76
    v_mul_f32 v80, v80, v20
    v_mul_f32 v81, v81, v20
    v_mul_f32 v82, v82, v20
    v_mul_f32 v83, v83, v20
    v_cvt_pk_bf16_f32 v84, v80, v81
    v_lshlrev_b32 v80, 16, v84
    v_and_b32 v81, 0xffff0000, v84
    v_cvt_pk_bf16_f32 v84, v82, v83
    v_lshlrev_b32 v82, 16, v84
    v_and_b32 v83, 0xffff0000, v84
    v_cvt_pk_bf16_f32 v84, v56, v57
    v_lshlrev_b32 v56, 16, v84
    v_and_b32 v57, 0xffff0000, v84
    v_cvt_pk_bf16_f32 v84, v58, v59
    v_lshlrev_b32 v58, 16, v84
    v_and_b32 v59, 0xffff0000, v84
    v_add_f32 v56, v56, v80
    v_add_f32 v57, v57, v81
    v_add_f32 v58, v58, v82
    v_add_f32 v59, v59, v83
    v_cvt_pk_bf16_f32 v86, v56, v57
    v_cvt_pk_bf16_f32 v87, v58, v59
    buffer_store_dwordx2 v[86:87], v19, s[56:59], 0 offen offset:3072
    v_and_b32 v80, 0xffff0000, v79
    v_lshlrev_b32 v81, 16, v79
    v_and_b32 v82, 0xffff0000, v78
    v_lshlrev_b32 v83, 16, v78
    v_mul_f32 v80, v80, v20
    v_mul_f32 v81, v81, v20
    v_mul_f32 v82, v82, v20
    v_mul_f32 v83, v83, v20
    v_cvt_pk_bf16_f32 v84, v80, v81
    v_lshlrev_b32 v80, 16, v84
    v_and_b32 v81, 0xffff0000, v84
    v_cvt_pk_bf16_f32 v84, v82, v83
    v_lshlrev_b32 v82, 16, v84
    v_and_b32 v83, 0xffff0000, v84
    v_cvt_pk_bf16_f32 v84, v60, v61
    v_lshlrev_b32 v60, 16, v84
    v_and_b32 v61, 0xffff0000, v84
    v_cvt_pk_bf16_f32 v84, v62, v63
    v_lshlrev_b32 v62, 16, v84
    v_and_b32 v63, 0xffff0000, v84
    v_add_f32 v60, v60, v80
    v_add_f32 v61, v61, v81
    v_add_f32 v62, v62, v82
    v_add_f32 v63, v63, v83
    v_cvt_pk_bf16_f32 v88, v60, v61
    v_cvt_pk_bf16_f32 v89, v62, v63
    buffer_store_dwordx2 v[88:89], v19, s[56:59], 0 offen offset:3584
    s_endpgm
g1_extra:
    s_cmp_ge_u32 s16, 8
    s_cbranch_scc1 g1_convx
    s_mov_b32 s20, s74
    s_mov_b32 s21, s75
    s_mov_b32 s22, 14680064
    s_mov_b32 s23, 0x00020000
    s_sub_u32 s17, s2, 224
    s_lshl_b32 s17, s17, 3
    s_add_u32 s17, s17, s16
    s_mul_i32 s17, s17, 57344
    v_lshl_add_u32 v4, v1, 4, s17
    s_mov_b32 s18, 0
g1_pfl:
    buffer_load_dwordx4 v[8:11], v4, s[20:23], s18 offen
    s_add_u32 s18, s18, 1024
    buffer_load_dwordx4 v[12:15], v4, s[20:23], s18 offen
    s_add_u32 s18, s18, 1024
    s_cmp_lt_u32 s18, 57344
    s_cbranch_scc1 g1_pfl
    s_endpgm
g1_done:
    s_endpgm
.globl gemm2_kernel
.p2align 8
.type gemm2_kernel,@function
gemm2_kernel:
    s_cmp_ge_u32 s2, 256
    s_cbranch_scc1 g2_done
    s_load_dwordx4 s[4:7], s[0:1], 72
    s_load_dwordx2 s[8:9], s[0:1], 104
    s_load_dwordx2 s[44:45], s[0:1], 0
    s_load_dwordx2 s[46:47], s[0:1], 88
    s_and_b32 s10, s2, 7
    s_lshr_b32 s11, s2, 3
    s_and_b32 s12, s10, 1
    s_lshl_b32 s12, s12, 2
    s_and_b32 s13, s11, 3
    s_add_u32 s14, s12, s13
    s_lshr_b32 s12, s10, 1
    s_lshl_b32 s12, s12, 3
    s_lshr_b32 s13, s11, 2
    s_add_u32 s15, s12, s13
    v_and_b32 v1, 63, v0
    v_lshrrev_b32 v2, 6, v0
    s_nop 0
    v_readfirstlane_b32 s16, v2
    s_waitcnt lgkmcnt(0)
    s_add_u32 s20, s8, 16777216
    s_addc_u32 s21, s9, 0
    s_mov_b32 s22, 7340032
    s_mov_b32 s23, 0x00020000
    s_mov_b32 s24, s4
    s_mov_b32 s25, s5
    s_mov_b32 s26, 14680064
    s_mov_b32 s27, 0x00020000
    s_cmp_ge_u32 s16, 4
    s_cbranch_scc1 g2_loader
    s_mov_b32 s28, s46
    s_mov_b32 s29, s47
    s_mov_b32 s30, 4194304
    s_mov_b32 s31, 0x00020000
    s_add_u32 s48, s8, 4194304
    s_addc_u32 s49, s9, 0
    s_mov_b32 s50, 16384
    s_mov_b32 s51, 0x00020000
    s_mov_b32 s56, s6
    s_mov_b32 s57, s7
    s_mov_b32 s58, 4096
    s_mov_b32 s59, 0x00020000
    s_and_b32 s17, s16, 1
    s_lshr_b32 s18, s16, 1
    v_lshrrev_b32 v3, 4, v1
    v_bfe_u32 v4, v1, 2, 2
    v_and_b32 v5, 3, v1
    v_and_b32 v6, 15, v1
    s_lshl_b32 s41, s15, 6
    s_lshl_b32 s42, s18, 5
    s_add_u32 s41, s41, s42
    v_add_u32 v16, s41, v6
    s_lshl_b32 s41, s14, 7
    s_lshl_b32 s42, s17, 6
    s_add_u32 s41, s41, s42
    v_lshl_add_u32 v17, v3, 4, s41
    v_lshlrev_b32 v18, 11, v16
    v_lshl_add_u32 v18, v17, 1, v18
    v_lshlrev_b32 v20, 3, v16
    v_lshlrev_b32 v21, 1, v16
    buffer_load_dwordx2 v[24:25], v20, s[48:51], 0 offen offset:0
    buffer_load_ushort v28, v21, s[56:59], 0 offen offset:0
    buffer_load_dwordx2 v[26:27], v20, s[48:51], 0 offen offset:128
    buffer_load_ushort v29, v21, s[56:59], 0 offen offset:32
    s_lshl_b32 s36, s18, 13
    v_lshlrev_b32 v19, 8, v6
    v_add_u32 v19, s36, v19
    v_and_b32 v22, 1, v3
    v_lshl_add_u32 v19, v22, 3, v19
    v_add_u32 v19, 122880, v19
    v_lshrrev_b32 v22, 1, v3
    s_lshl_b32 s36, s17, 3
    v_add_u32 v22, s36, v22
    v_add_u32 v23, 0, v22
    v_xor_b32 v23, v23, v6
    v_lshl_add_u32 v112, v23, 4, v19
    v_add_u32 v23, 2, v22
    v_xor_b32 v23, v23, v6
    v_lshl_add_u32 v113, v23, 4, v19
    v_add_u32 v23, 4, v22
    v_xor_b32 v23, v23, v6
    v_lshl_add_u32 v114, v23, 4, v19
    v_add_u32 v23, 6, v22
    v_xor_b32 v23, v23, v6
    v_lshl_add_u32 v115, v23, 4, v19
    s_lshl_b32 s19, s17, 12
    v_lshl_add_u32 v8, v1, 4, s19
    v_lshrrev_b32 v7, 1, v4
    v_and_b32 v10, 1, v3
    v_lshl_or_b32 v7, v10, 1, v7
    v_lshl_add_u32 v12, v3, 2, v4
    v_lshlrev_b32 v12, 7, v12
    v_lshl_add_u32 v12, v5, 3, v12
    s_lshl_b32 s19, s18, 1
    s_lshl_b32 s37, s17, 13
    s_add_u32 s37, s37, 139264
    s_add_u32 s36, s19, 0
    v_xor_b32 v9, s36, v7
    v_lshl_add_u32 v9, v9, 5, v12
    v_add_u32 v116, s37, v9
    v_add_u32 v9, 0x4000, v9
    s_add_u32 s36, s19, 1
    v_xor_b32 v10, s36, v7
    v_lshl_add_u32 v10, v10, 5, v12
    v_add_u32 v117, s37, v10
    v_add_u32 v10, 0x4000, v10
    v_mov_b32 v12, v8
    v_mov_b32 v13, v9
    v_mov_b32 v14, v10
    v_mov_b32 v80, 0
    v_mov_b32 v81, 0
    v_mov_b32 v82, 0
    v_mov_b32 v83, 0
    v_mov_b32 v84, 0
    v_mov_b32 v85, 0
    v_mov_b32 v86, 0
    v_mov_b32 v87, 0
    v_mov_b32 v88, 0
    v_mov_b32 v89, 0
    v_mov_b32 v90, 0
    v_mov_b32 v91, 0
    v_mov_b32 v92, 0
    v_mov_b32 v93, 0
    v_mov_b32 v94, 0
    v_mov_b32 v95, 0
    v_mov_b32 v96, 0
    v_mov_b32 v97, 0
    v_mov_b32 v98, 0
    v_mov_b32 v99, 0
    v_mov_b32 v100, 0
    v_mov_b32 v101, 0
    v_mov_b32 v102, 0
    v_mov_b32 v103, 0
    v_mov_b32 v104, 0
    v_mov_b32 v105, 0
    v_mov_b32 v106, 0
    v_mov_b32 v107, 0
    v_mov_b32 v108, 0
    v_mov_b32 v109, 0
    v_mov_b32 v110, 0
    v_mov_b32 v111, 0
    s_mov_b32 s39, 0
    s_mov_b32 s40, 0
    s_barrier
    ds_read_b64_tr_b16 v[48:49], v13 offset:0
    ds_read_b64_tr_b16 v[50:51], v13 offset:2048
    ds_read_b64_tr_b16 v[52:53], v14 offset:0
    ds_read_b64_tr_b16 v[54:55], v14 offset:2048
    ds_read_b128 v[32:35], v12 offset:0
    ds_read_b128 v[36:39], v12 offset:1024
    ds_read_b128 v[40:43], v12 offset:2048
    ds_read_b128 v[44:47], v12 offset:3072
g2_cloop:
    s_waitcnt lgkmcnt(0)
    v_mfma_f32_16x16x32_bf16 v[80:83], v[32:35], v[48:51], v[80:83]
    ds_read_b64_tr_b16 v[72:73], v13 offset:4096
    ds_read_b64_tr_b16 v[74:75], v13 offset:6144
    v_mfma_f32_16x16x32_bf16 v[84:87], v[32:35], v[52:55], v[84:87]
    ds_read_b64_tr_b16 v[76:77], v14 offset:4096
    ds_read_b64_tr_b16 v[78:79], v14 offset:6144
    v_mfma_f32_16x16x32_bf16 v[88:91], v[36:39], v[48:51], v[88:91]
    ds_read_b128 v[56:59], v12 offset:8192
    ds_read_b128 v[60:63], v12 offset:9216
    v_mfma_f32_16x16x32_bf16 v[92:95], v[36:39], v[52:55], v[92:95]
    ds_read_b128 v[64:67], v12 offset:10240
    ds_read_b128 v[68:71], v12 offset:11264
    v_mfma_f32_16x16x32_bf16 v[96:99], v[40:43], v[48:51], v[96:99]
    v_mfma_f32_16x16x32_bf16 v[100:103], v[40:43], v[52:55], v[100:103]
    v_mfma_f32_16x16x32_bf16 v[104:107], v[44:47], v[48:51], v[104:107]
    v_mfma_f32_16x16x32_bf16 v[108:111], v[44:47], v[52:55], v[108:111]
    s_waitcnt lgkmcnt(0)
    s_barrier
    s_add_u32 s39, s39, 24576
    s_cmp_eq_u32 s39, 122880
    s_cselect_b32 s39, 0, s39
    v_mfma_f32_16x16x32_bf16 v[80:83], v[56:59], v[72:75], v[80:83]
    v_add_u32 v12, s39, v8
    v_add_u32 v13, s39, v9
    v_add_u32 v14, s39, v10
    v_mfma_f32_16x16x32_bf16 v[84:87], v[56:59], v[76:79], v[84:87]
    ds_read_b64_tr_b16 v[48:49], v13 offset:0
    ds_read_b64_tr_b16 v[50:51], v13 offset:2048
    v_mfma_f32_16x16x32_bf16 v[88:91], v[60:63], v[72:75], v[88:91]
    ds_read_b64_tr_b16 v[52:53], v14 offset:0
    ds_read_b64_tr_b16 v[54:55], v14 offset:2048
    v_mfma_f32_16x16x32_bf16 v[92:95], v[60:63], v[76:79], v[92:95]
    ds_read_b128 v[32:35], v12 offset:0
    ds_read_b128 v[36:39], v12 offset:1024
    v_mfma_f32_16x16x32_bf16 v[96:99], v[64:67], v[72:75], v[96:99]
    ds_read_b128 v[40:43], v12 offset:2048
    ds_read_b128 v[44:47], v12 offset:3072
    v_mfma_f32_16x16x32_bf16 v[100:103], v[64:67], v[76:79], v[100:103]
    v_mfma_f32_16x16x32_bf16 v[104:107], v[68:71], v[72:75], v[104:107]
    v_mfma_f32_16x16x32_bf16 v[108:111], v[68:71], v[76:79], v[108:111]
    s_sub_u32 s36, s40, 4
    s_cmp_gt_u32 s36, 7
    s_cbranch_scc1 g2_noxa
    s_cmp_lg_u32 s40, 4
    s_cbranch_scc1 g2_blk4
    s_waitcnt vmcnt(0)
    v_lshlrev_b32 v28, 16, v28
    v_rcp_f32 v30, v25
    v_lshlrev_b32 v29, 16, v29
    v_rcp_f32 v31, v27
    ds_read_b64 v[120:121], v112 offset:0
    ds_read_b64_tr_b16 v[154:155], v116 offset:0
    s_waitcnt lgkmcnt(0)
    v_lshlrev_b32 v140, 16, v120
    v_and_b32 v141, 0xffff0000, v120
    v_lshlrev_b32 v142, 16, v121
    v_and_b32 v143, 0xffff0000, v121
    v_sub_f32 v144, v140, v24
    v_sub_f32 v145, v141, v24
    v_sub_f32 v146, v142, v24
    v_sub_f32 v147, v143, v24
    v_cvt_pk_bf16_f32 v152, v144, v145
    v_lshlrev_b32 v144, 16, v152
    v_and_b32 v145, 0xffff0000, v152
    v_cvt_pk_bf16_f32 v152, v146, v147
    v_lshlrev_b32 v146, 16, v152
    v_and_b32 v147, 0xffff0000, v152
    v_mul_f32 v148, v144, v30
    v_fma_f32 v144, -v148, v25, v144
    v_fmac_f32 v148, v144, v30
    v_mul_f32 v149, v145, v30
    v_fma_f32 v145, -v149, v25, v145
    v_fmac_f32 v149, v145, v30
    v_mul_f32 v150, v146, v30
    v_fma_f32 v146, -v150, v25, v146
    v_fmac_f32 v150, v146, v30
    v_mul_f32 v151, v147, v30
    v_fma_f32 v147, -v151, v25, v147
    v_fmac_f32 v151, v147, v30
    v_cvt_pk_bf16_f32 v152, v148, v149
    v_lshlrev_b32 v148, 16, v152
    v_and_b32 v149, 0xffff0000, v152
    v_cvt_pk_bf16_f32 v152, v150, v151
    v_lshlrev_b32 v150, 16, v152
    v_and_b32 v151, 0xffff0000, v152
    v_lshlrev_b32 v144, 16, v154
    v_and_b32 v145, 0xffff0000, v154
    v_lshlrev_b32 v146, 16, v155
    v_and_b32 v147, 0xffff0000, v155
    v_mul_f32 v148, v148, v144
    v_mul_f32 v149, v149, v145
    v_mul_f32 v150, v150, v146
    v_mul_f32 v151, v151, v147
    v_cvt_pk_bf16_f32 v152, v148, v149
    v_lshlrev_b32 v148, 16, v152
    v_and_b32 v149, 0xffff0000, v152
    v_cvt_pk_bf16_f32 v152, v150, v151
    v_lshlrev_b32 v150, 16, v152
    v_and_b32 v151, 0xffff0000, v152
    v_add_f32 v140, v140, v148
    v_add_f32 v141, v141, v149
    v_add_f32 v142, v142, v150
    v_add_f32 v143, v143, v151
    v_cvt_pk_bf16_f32 v120, v140, v141
    v_cvt_pk_bf16_f32 v121, v142, v143
    s_branch g2_noxa
g2_blk4:
    s_cmp_lg_u32 s40, 5
    s_cbranch_scc1 g2_blk5
    ds_read_b64 v[124:125], v113 offset:0
    ds_read_b64_tr_b16 v[154:155], v116 offset:2048
    s_waitcnt lgkmcnt(0)
    v_lshlrev_b32 v140, 16, v124
    v_and_b32 v141, 0xffff0000, v124
    v_lshlrev_b32 v142, 16, v125
    v_and_b32 v143, 0xffff0000, v125
    v_sub_f32 v144, v140, v24
    v_sub_f32 v145, v141, v24
    v_sub_f32 v146, v142, v24
    v_sub_f32 v147, v143, v24
    v_cvt_pk_bf16_f32 v152, v144, v145
    v_lshlrev_b32 v144, 16, v152
    v_and_b32 v145, 0xffff0000, v152
    v_cvt_pk_bf16_f32 v152, v146, v147
    v_lshlrev_b32 v146, 16, v152
    v_and_b32 v147, 0xffff0000, v152
    v_mul_f32 v148, v144, v30
    v_fma_f32 v144, -v148, v25, v144
    v_fmac_f32 v148, v144, v30
    v_mul_f32 v149, v145, v30
    v_fma_f32 v145, -v149, v25, v145
    v_fmac_f32 v149, v145, v30
    v_mul_f32 v150, v146, v30
    v_fma_f32 v146, -v150, v25, v146
    v_fmac_f32 v150, v146, v30
    v_mul_f32 v151, v147, v30
    v_fma_f32 v147, -v151, v25, v147
    v_fmac_f32 v151, v147, v30
    v_cvt_pk_bf16_f32 v152, v148, v149
    v_lshlrev_b32 v148, 16, v152
    v_and_b32 v149, 0xffff0000, v152
    v_cvt_pk_bf16_f32 v152, v150, v151
    v_lshlrev_b32 v150, 16, v152
    v_and_b32 v151, 0xffff0000, v152
    v_lshlrev_b32 v144, 16, v154
    v_and_b32 v145, 0xffff0000, v154
    v_lshlrev_b32 v146, 16, v155
    v_and_b32 v147, 0xffff0000, v155
    v_mul_f32 v148, v148, v144
    v_mul_f32 v149, v149, v145
    v_mul_f32 v150, v150, v146
    v_mul_f32 v151, v151, v147
    v_cvt_pk_bf16_f32 v152, v148, v149
    v_lshlrev_b32 v148, 16, v152
    v_and_b32 v149, 0xffff0000, v152
    v_cvt_pk_bf16_f32 v152, v150, v151
    v_lshlrev_b32 v150, 16, v152
    v_and_b32 v151, 0xffff0000, v152
    v_add_f32 v140, v140, v148
    v_add_f32 v141, v141, v149
    v_add_f32 v142, v142, v150
    v_add_f32 v143, v143, v151
    v_cvt_pk_bf16_f32 v124, v140, v141
    v_cvt_pk_bf16_f32 v125, v142, v143
    s_branch g2_noxa
g2_blk5:
    s_cmp_lg_u32 s40, 6
    s_cbranch_scc1 g2_blk6
    ds_read_b64 v[128:129], v114 offset:0
    ds_read_b64_tr_b16 v[154:155], v116 offset:4096
    s_waitcnt lgkmcnt(0)
    v_lshlrev_b32 v140, 16, v128
    v_and_b32 v141, 0xffff0000, v128
    v_lshlrev_b32 v142, 16, v129
    v_and_b32 v143, 0xffff0000, v129
    v_sub_f32 v144, v140, v24
    v_sub_f32 v145, v141, v24
    v_sub_f32 v146, v142, v24
    v_sub_f32 v147, v143, v24
    v_cvt_pk_bf16_f32 v152, v144, v145
    v_lshlrev_b32 v144, 16, v152
    v_and_b32 v145, 0xffff0000, v152
    v_cvt_pk_bf16_f32 v152, v146, v147
    v_lshlrev_b32 v146, 16, v152
    v_and_b32 v147, 0xffff0000, v152
    v_mul_f32 v148, v144, v30
    v_fma_f32 v144, -v148, v25, v144
    v_fmac_f32 v148, v144, v30
    v_mul_f32 v149, v145, v30
    v_fma_f32 v145, -v149, v25, v145
    v_fmac_f32 v149, v145, v30
    v_mul_f32 v150, v146, v30
    v_fma_f32 v146, -v150, v25, v146
    v_fmac_f32 v150, v146, v30
    v_mul_f32 v151, v147, v30
    v_fma_f32 v147, -v151, v25, v147
    v_fmac_f32 v151, v147, v30
    v_cvt_pk_bf16_f32 v152, v148, v149
    v_lshlrev_b32 v148, 16, v152
    v_and_b32 v149, 0xffff0000, v152
    v_cvt_pk_bf16_f32 v152, v150, v151
    v_lshlrev_b32 v150, 16, v152
    v_and_b32 v151, 0xffff0000, v152
    v_lshlrev_b32 v144, 16, v154
    v_and_b32 v145, 0xffff0000, v154
    v_lshlrev_b32 v146, 16, v155
    v_and_b32 v147, 0xffff0000, v155
    v_mul_f32 v148, v148, v144
    v_mul_f32 v149, v149, v145
    v_mul_f32 v150, v150, v146
    v_mul_f32 v151, v151, v147
    v_cvt_pk_bf16_f32 v152, v148, v149
    v_lshlrev_b32 v148, 16, v152
    v_and_b32 v149, 0xffff0000, v152
    v_cvt_pk_bf16_f32 v152, v150, v151
    v_lshlrev_b32 v150, 16, v152
    v_and_b32 v151, 0xffff0000, v152
    v_add_f32 v140, v140, v148
    v_add_f32 v141, v141, v149
    v_add_f32 v142, v142, v150
    v_add_f32 v143, v143, v151
    v_cvt_pk_bf16_f32 v128, v140, v141
    v_cvt_pk_bf16_f32 v129, v142, v143
    s_branch g2_noxa
g2_blk6:
    s_cmp_lg_u32 s40, 7
    s_cbranch_scc1 g2_blk7
    ds_read_b64 v[132:133], v115 offset:0
    ds_read_b64_tr_b16 v[154:155], v116 offset:6144
    s_waitcnt lgkmcnt(0)
    v_lshlrev_b32 v140, 16, v132
    v_and_b32 v141, 0xffff0000, v132
    v_lshlrev_b32 v142, 16, v133
    v_and_b32 v143, 0xffff0000, v133
    v_sub_f32 v144, v140, v24
    v_sub_f32 v145, v141, v24
    v_sub_f32 v146, v142, v24
    v_sub_f32 v147, v143, v24
    v_cvt_pk_bf16_f32 v152, v144, v145
    v_lshlrev_b32 v144, 16, v152
    v_and_b32 v145, 0xffff0000, v152
    v_cvt_pk_bf16_f32 v152, v146, v147
    v_lshlrev_b32 v146, 16, v152
    v_and_b32 v147, 0xffff0000, v152
    v_mul_f32 v148, v144, v30
    v_fma_f32 v144, -v148, v25, v144
    v_fmac_f32 v148, v144, v30
    v_mul_f32 v149, v145, v30
    v_fma_f32 v145, -v149, v25, v145
    v_fmac_f32 v149, v145, v30
    v_mul_f32 v150, v146, v30
    v_fma_f32 v146, -v150, v25, v146
    v_fmac_f32 v150, v146, v30
    v_mul_f32 v151, v147, v30
    v_fma_f32 v147, -v151, v25, v147
    v_fmac_f32 v151, v147, v30
    v_cvt_pk_bf16_f32 v152, v148, v149
    v_lshlrev_b32 v148, 16, v152
    v_and_b32 v149, 0xffff0000, v152
    v_cvt_pk_bf16_f32 v152, v150, v151
    v_lshlrev_b32 v150, 16, v152
    v_and_b32 v151, 0xffff0000, v152
    v_lshlrev_b32 v144, 16, v154
    v_and_b32 v145, 0xffff0000, v154
    v_lshlrev_b32 v146, 16, v155
    v_and_b32 v147, 0xffff0000, v155
    v_mul_f32 v148, v148, v144
    v_mul_f32 v149, v149, v145
    v_mul_f32 v150, v150, v146
    v_mul_f32 v151, v151, v147
    v_cvt_pk_bf16_f32 v152, v148, v149
    v_lshlrev_b32 v148, 16, v152
    v_and_b32 v149, 0xffff0000, v152
    v_cvt_pk_bf16_f32 v152, v150, v151
    v_lshlrev_b32 v150, 16, v152
    v_and_b32 v151, 0xffff0000, v152
    v_add_f32 v140, v140, v148
    v_add_f32 v141, v141, v149
    v_add_f32 v142, v142, v150
    v_add_f32 v143, v143, v151
    v_cvt_pk_bf16_f32 v132, v140, v141
    v_cvt_pk_bf16_f32 v133, v142, v143
    s_branch g2_noxa
g2_blk7:
    s_cmp_lg_u32 s40, 8
    s_cbranch_scc1 g2_blk8
    ds_read_b64 v[122:123], v112 offset:4096
    ds_read_b64_tr_b16 v[154:155], v117 offset:0
    s_waitcnt lgkmcnt(0)
    v_lshlrev_b32 v140, 16, v122
    v_and_b32 v141, 0xffff0000, v122
    v_lshlrev_b32 v142, 16, v123
    v_and_b32 v143, 0xffff0000, v123
    v_sub_f32 v144, v140, v26
    v_sub_f32 v145, v141, v26
    v_sub_f32 v146, v142, v26
    v_sub_f32 v147, v143, v26
    v_cvt_pk_bf16_f32 v152, v144, v145
    v_lshlrev_b32 v144, 16, v152
    v_and_b32 v145, 0xffff0000, v152
    v_cvt_pk_bf16_f32 v152, v146, v147
    v_lshlrev_b32 v146, 16, v152
    v_and_b32 v147, 0xffff0000, v152
    v_mul_f32 v148, v144, v31
    v_fma_f32 v144, -v148, v27, v144
    v_fmac_f32 v148, v144, v31
    v_mul_f32 v149, v145, v31
    v_fma_f32 v145, -v149, v27, v145
    v_fmac_f32 v149, v145, v31
    v_mul_f32 v150, v146, v31
    v_fma_f32 v146, -v150, v27, v146
    v_fmac_f32 v150, v146, v31
    v_mul_f32 v151, v147, v31
    v_fma_f32 v147, -v151, v27, v147
    v_fmac_f32 v151, v147, v31
    v_cvt_pk_bf16_f32 v152, v148, v149
    v_lshlrev_b32 v148, 16, v152
    v_and_b32 v149, 0xffff0000, v152
    v_cvt_pk_bf16_f32 v152, v150, v151
    v_lshlrev_b32 v150, 16, v152
    v_and_b32 v151, 0xffff0000, v152
    v_lshlrev_b32 v144, 16, v154
    v_and_b32 v145, 0xffff0000, v154
    v_lshlrev_b32 v146, 16, v155
    v_and_b32 v147, 0xffff0000, v155
    v_mul_f32 v148, v148, v144
    v_mul_f32 v149, v149, v145
    v_mul_f32 v150, v150, v146
    v_mul_f32 v151, v151, v147
    v_cvt_pk_bf16_f32 v152, v148, v149
    v_lshlrev_b32 v148, 16, v152
    v_and_b32 v149, 0xffff0000, v152
    v_cvt_pk_bf16_f32 v152, v150, v151
    v_lshlrev_b32 v150, 16, v152
    v_and_b32 v151, 0xffff0000, v152
    v_add_f32 v140, v140, v148
    v_add_f32 v141, v141, v149
    v_add_f32 v142, v142, v150
    v_add_f32 v143, v143, v151
    v_cvt_pk_bf16_f32 v122, v140, v141
    v_cvt_pk_bf16_f32 v123, v142, v143
    s_branch g2_noxa
g2_blk8:
    s_cmp_lg_u32 s40, 9
    s_cbranch_scc1 g2_blk9
    ds_read_b64 v[126:127], v113 offset:4096
    ds_read_b64_tr_b16 v[154:155], v117 offset:2048
    s_waitcnt lgkmcnt(0)
    v_lshlrev_b32 v140, 16, v126
    v_and_b32 v141, 0xffff0000, v126
    v_lshlrev_b32 v142, 16, v127
    v_and_b32 v143, 0xffff0000, v127
    v_sub_f32 v144, v140, v26
    v_sub_f32 v145, v141, v26
    v_sub_f32 v146, v142, v26
    v_sub_f32 v147, v143, v26
    v_cvt_pk_bf16_f32 v152, v144, v145
    v_lshlrev_b32 v144, 16, v152
    v_and_b32 v145, 0xffff0000, v152
    v_cvt_pk_bf16_f32 v152, v146, v147
    v_lshlrev_b32 v146, 16, v152
    v_and_b32 v147, 0xffff0000, v152
    v_mul_f32 v148, v144, v31
    v_fma_f32 v144, -v148, v27, v144
    v_fmac_f32 v148, v144, v31
    v_mul_f32 v149, v145, v31
    v_fma_f32 v145, -v149, v27, v145
    v_fmac_f32 v149, v145, v31
    v_mul_f32 v150, v146, v31
    v_fma_f32 v146, -v150, v27, v146
    v_fmac_f32 v150, v146, v31
    v_mul_f32 v151, v147, v31
    v_fma_f32 v147, -v151, v27, v147
    v_fmac_f32 v151, v147, v31
    v_cvt_pk_bf16_f32 v152, v148, v149
    v_lshlrev_b32 v148, 16, v152
    v_and_b32 v149, 0xffff0000, v152
    v_cvt_pk_bf16_f32 v152, v150, v151
    v_lshlrev_b32 v150, 16, v152
    v_and_b32 v151, 0xffff0000, v152
    v_lshlrev_b32 v144, 16, v154
    v_and_b32 v145, 0xffff0000, v154
    v_lshlrev_b32 v146, 16, v155
    v_and_b32 v147, 0xffff0000, v155
    v_mul_f32 v148, v148, v144
    v_mul_f32 v149, v149, v145
    v_mul_f32 v150, v150, v146
    v_mul_f32 v151, v151, v147
    v_cvt_pk_bf16_f32 v152, v148, v149
    v_lshlrev_b32 v148, 16, v152
    v_and_b32 v149, 0xffff0000, v152
    v_cvt_pk_bf16_f32 v152, v150, v151
    v_lshlrev_b32 v150, 16, v152
    v_and_b32 v151, 0xffff0000, v152
    v_add_f32 v140, v140, v148
    v_add_f32 v141, v141, v149
    v_add_f32 v142, v142, v150
    v_add_f32 v143, v143, v151
    v_cvt_pk_bf16_f32 v126, v140, v141
    v_cvt_pk_bf16_f32 v127, v142, v143
    s_branch g2_noxa
g2_blk9:
    s_cmp_lg_u32 s40, 10
    s_cbranch_scc1 g2_blk10
    ds_read_b64 v[130:131], v114 offset:4096
    ds_read_b64_tr_b16 v[154:155], v117 offset:4096
    s_waitcnt lgkmcnt(0)
    v_lshlrev_b32 v140, 16, v130
    v_and_b32 v141, 0xffff0000, v130
    v_lshlrev_b32 v142, 16, v131
    v_and_b32 v143, 0xffff0000, v131
    v_sub_f32 v144, v140, v26
    v_sub_f32 v145, v141, v26
    v_sub_f32 v146, v142, v26
    v_sub_f32 v147, v143, v26
    v_cvt_pk_bf16_f32 v152, v144, v145
    v_lshlrev_b32 v144, 16, v152
    v_and_b32 v145, 0xffff0000, v152
    v_cvt_pk_bf16_f32 v152, v146, v147
    v_lshlrev_b32 v146, 16, v152
    v_and_b32 v147, 0xffff0000, v152
    v_mul_f32 v148, v144, v31
    v_fma_f32 v144, -v148, v27, v144
    v_fmac_f32 v148, v144, v31
    v_mul_f32 v149, v145, v31
    v_fma_f32 v145, -v149, v27, v145
    v_fmac_f32 v149, v145, v31
    v_mul_f32 v150, v146, v31
    v_fma_f32 v146, -v150, v27, v146
    v_fmac_f32 v150, v146, v31
    v_mul_f32 v151, v147, v31
    v_fma_f32 v147, -v151, v27, v147
    v_fmac_f32 v151, v147, v31
    v_cvt_pk_bf16_f32 v152, v148, v149
    v_lshlrev_b32 v148, 16, v152
    v_and_b32 v149, 0xffff0000, v152
    v_cvt_pk_bf16_f32 v152, v150, v151
    v_lshlrev_b32 v150, 16, v152
    v_and_b32 v151, 0xffff0000, v152
    v_lshlrev_b32 v144, 16, v154
    v_and_b32 v145, 0xffff0000, v154
    v_lshlrev_b32 v146, 16, v155
    v_and_b32 v147, 0xffff0000, v155
    v_mul_f32 v148, v148, v144
    v_mul_f32 v149, v149, v145
    v_mul_f32 v150, v150, v146
    v_mul_f32 v151, v151, v147
    v_cvt_pk_bf16_f32 v152, v148, v149
    v_lshlrev_b32 v148, 16, v152
    v_and_b32 v149, 0xffff0000, v152
    v_cvt_pk_bf16_f32 v152, v150, v151
    v_lshlrev_b32 v150, 16, v152
    v_and_b32 v151, 0xffff0000, v152
    v_add_f32 v140, v140, v148
    v_add_f32 v141, v141, v149
    v_add_f32 v142, v142, v150
    v_add_f32 v143, v143, v151
    v_cvt_pk_bf16_f32 v130, v140, v141
    v_cvt_pk_bf16_f32 v131, v142, v143
    s_branch g2_noxa
g2_blk10:
    s_cmp_lg_u32 s40, 11
    s_cbranch_scc1 g2_blk11
    ds_read_b64 v[134:135], v115 offset:4096
    ds_read_b64_tr_b16 v[154:155], v117 offset:6144
    s_waitcnt lgkmcnt(0)
    v_lshlrev_b32 v140, 16, v134
    v_and_b32 v141, 0xffff0000, v134
    v_lshlrev_b32 v142, 16, v135
    v_and_b32 v143, 0xffff0000, v135
    v_sub_f32 v144, v140, v26
    v_sub_f32 v145, v141, v26
    v_sub_f32 v146, v142, v26
    v_sub_f32 v147, v143, v26
    v_cvt_pk_bf16_f32 v152, v144, v145
    v_lshlrev_b32 v144, 16, v152
    v_and_b32 v145, 0xffff0000, v152
    v_cvt_pk_bf16_f32 v152, v146, v147
    v_lshlrev_b32 v146, 16, v152
    v_and_b32 v147, 0xffff0000, v152
    v_mul_f32 v148, v144, v31
    v_fma_f32 v144, -v148, v27, v144
    v_fmac_f32 v148, v144, v31
    v_mul_f32 v149, v145, v31
    v_fma_f32 v145, -v149, v27, v145
    v_fmac_f32 v149, v145, v31
    v_mul_f32 v150, v146, v31
    v_fma_f32 v146, -v150, v27, v146
    v_fmac_f32 v150, v146, v31
    v_mul_f32 v151, v147, v31
    v_fma_f32 v147, -v151, v27, v147
    v_fmac_f32 v151, v147, v31
    v_cvt_pk_bf16_f32 v152, v148, v149
    v_lshlrev_b32 v148, 16, v152
    v_and_b32 v149, 0xffff0000, v152
    v_cvt_pk_bf16_f32 v152, v150, v151
    v_lshlrev_b32 v150, 16, v152
    v_and_b32 v151, 0xffff0000, v152
    v_lshlrev_b32 v144, 16, v154
    v_and_b32 v145, 0xffff0000, v154
    v_lshlrev_b32 v146, 16, v155
    v_and_b32 v147, 0xffff0000, v155
    v_mul_f32 v148, v148, v144
    v_mul_f32 v149, v149, v145
    v_mul_f32 v150, v150, v146
    v_mul_f32 v151, v151, v147
    v_cvt_pk_bf16_f32 v152, v148, v149
    v_lshlrev_b32 v148, 16, v152
    v_and_b32 v149, 0xffff0000, v152
    v_cvt_pk_bf16_f32 v152, v150, v151
    v_lshlrev_b32 v150, 16, v152
    v_and_b32 v151, 0xffff0000, v152
    v_add_f32 v140, v140, v148
    v_add_f32 v141, v141, v149
    v_add_f32 v142, v142, v150
    v_add_f32 v143, v143, v151
    v_cvt_pk_bf16_f32 v134, v140, v141
    v_cvt_pk_bf16_f32 v135, v142, v143
    s_branch g2_noxa
g2_blk11:
g2_noxa:
    s_add_u32 s40, s40, 1
    s_cmp_lt_u32 s40, 56
    s_cbranch_scc1 g2_cloop
    s_waitcnt lgkmcnt(0)
    s_nop 7
    v_cvt_pk_bf16_f32 v152, v80, v81
    v_lshlrev_b32 v80, 16, v152
    v_and_b32 v81, 0xffff0000, v152
    v_cvt_pk_bf16_f32 v152, v82, v83
    v_lshlrev_b32 v82, 16, v152
    v_and_b32 v83, 0xffff0000, v152
    v_add_f32 v80, v80, v28
    v_add_f32 v81, v81, v28
    v_add_f32 v82, v82, v28
    v_add_f32 v83, v83, v28
    v_cvt_pk_bf16_f32 v152, v80, v81
    v_lshlrev_b32 v80, 16, v152
    v_and_b32 v81, 0xffff0000, v152
    v_cvt_pk_bf16_f32 v152, v82, v83
    v_lshlrev_b32 v82, 16, v152
    v_and_b32 v83, 0xffff0000, v152
    v_lshlrev_b32 v140, 16, v120
    v_and_b32 v141, 0xffff0000, v120
    v_lshlrev_b32 v142, 16, v121
    v_and_b32 v143, 0xffff0000, v121
    v_add_f32 v140, v140, v80
    v_add_f32 v141, v141, v81
    v_add_f32 v142, v142, v82
    v_add_f32 v143, v143, v83
    v_cvt_pk_bf16_f32 v32, v140, v141
    v_cvt_pk_bf16_f32 v33, v142, v143
    v_cvt_pk_bf16_f32 v152, v88, v89
    v_lshlrev_b32 v88, 16, v152
    v_and_b32 v89, 0xffff0000, v152
    v_cvt_pk_bf16_f32 v152, v90, v91
    v_lshlrev_b32 v90, 16, v152
    v_and_b32 v91, 0xffff0000, v152
    v_add_f32 v88, v88, v28
    v_add_f32 v89, v89, v28
    v_add_f32 v90, v90, v28
    v_add_f32 v91, v91, v28
    v_cvt_pk_bf16_f32 v152, v88, v89
    v_lshlrev_b32 v88, 16, v152
    v_and_b32 v89, 0xffff0000, v152
    v_cvt_pk_bf16_f32 v152, v90, v91
    v_lshlrev_b32 v90, 16, v152
    v_and_b32 v91, 0xffff0000, v152
    v_lshlrev_b32 v140, 16, v124
    v_and_b32 v141, 0xffff0000, v124
    v_lshlrev_b32 v142, 16, v125
    v_and_b32 v143, 0xffff0000, v125
    v_add_f32 v140, v140, v88
    v_add_f32 v141, v141, v89
    v_add_f32 v142, v142, v90
    v_add_f32 v143, v143, v91
    v_cvt_pk_bf16_f32 v34, v140, v141
    v_cvt_pk_bf16_f32 v35, v142, v143
    v_cvt_pk_bf16_f32 v152, v96, v97
    v_lshlrev_b32 v96, 16, v152
    v_and_b32 v97, 0xffff0000, v152
    v_cvt_pk_bf16_f32 v152, v98, v99
    v_lshlrev_b32 v98, 16, v152
    v_and_b32 v99, 0xffff0000, v152
    v_add_f32 v96, v96, v28
    v_add_f32 v97, v97, v28
    v_add_f32 v98, v98, v28
    v_add_f32 v99, v99, v28
    v_cvt_pk_bf16_f32 v152, v96, v97
    v_lshlrev_b32 v96, 16, v152
    v_and_b32 v97, 0xffff0000, v152
    v_cvt_pk_bf16_f32 v152, v98, v99
    v_lshlrev_b32 v98, 16, v152
    v_and_b32 v99, 0xffff0000, v152
    v_lshlrev_b32 v140, 16, v128
    v_and_b32 v141, 0xffff0000, v128
    v_lshlrev_b32 v142, 16, v129
    v_and_b32 v143, 0xffff0000, v129
    v_add_f32 v140, v140, v96
    v_add_f32 v141, v141, v97
    v_add_f32 v142, v142, v98
    v_add_f32 v143, v143, v99
    v_cvt_pk_bf16_f32 v36, v140, v141
    v_cvt_pk_bf16_f32 v37, v142, v143
    v_cvt_pk_bf16_f32 v152, v104, v105
    v_lshlrev_b32 v104, 16, v152
    v_and_b32 v105, 0xffff0000, v152
    v_cvt_pk_bf16_f32 v152, v106, v107
    v_lshlrev_b32 v106, 16, v152
    v_and_b32 v107, 0xffff0000, v152
    v_add_f32 v104, v104, v28
    v_add_f32 v105, v105, v28
    v_add_f32 v106, v106, v28
    v_add_f32 v107, v107, v28
    v_cvt_pk_bf16_f32 v152, v104, v105
    v_lshlrev_b32 v104, 16, v152
    v_and_b32 v105, 0xffff0000, v152
    v_cvt_pk_bf16_f32 v152, v106, v107
    v_lshlrev_b32 v106, 16, v152
    v_and_b32 v107, 0xffff0000, v152
    v_lshlrev_b32 v140, 16, v132
    v_and_b32 v141, 0xffff0000, v132
    v_lshlrev_b32 v142, 16, v133
    v_and_b32 v143, 0xffff0000, v133
    v_add_f32 v140, v140, v104
    v_add_f32 v141, v141, v105
    v_add_f32 v142, v142, v106
    v_add_f32 v143, v143, v107
    v_cvt_pk_bf16_f32 v38, v140, v141
    v_cvt_pk_bf16_f32 v39, v142, v143
    s_nop 1
    v_permlane32_swap_b32 v32, v36
    v_permlane32_swap_b32 v34, v38
    v_permlane32_swap_b32 v33, v37
    v_permlane32_swap_b32 v35, v39
    s_nop 1
    v_permlane16_swap_b32 v32, v34
    v_permlane16_swap_b32 v36, v38
    v_permlane16_swap_b32 v33, v35
    v_permlane16_swap_b32 v37, v39
    v_add_u32 v22, 0, v18
    buffer_store_dwordx4 v[32:35], v22, s[28:31], 0 offen
    buffer_store_dwordx4 v[36:39], v22, s[28:31], 0 offen offset:16
    v_cvt_pk_bf16_f32 v152, v84, v85
    v_lshlrev_b32 v84, 16, v152
    v_and_b32 v85, 0xffff0000, v152
    v_cvt_pk_bf16_f32 v152, v86, v87
    v_lshlrev_b32 v86, 16, v152
    v_and_b32 v87, 0xffff0000, v152
    v_add_f32 v84, v84, v29
    v_add_f32 v85, v85, v29
    v_add_f32 v86, v86, v29
    v_add_f32 v87, v87, v29
    v_cvt_pk_bf16_f32 v152, v84, v85
    v_lshlrev_b32 v84, 16, v152
    v_and_b32 v85, 0xffff0000, v152
    v_cvt_pk_bf16_f32 v152, v86, v87
    v_lshlrev_b32 v86, 16, v152
    v_and_b32 v87, 0xffff0000, v152
    v_lshlrev_b32 v140, 16, v122
    v_and_b32 v141, 0xffff0000, v122
    v_lshlrev_b32 v142, 16, v123
    v_and_b32 v143, 0xffff0000, v123
    v_add_f32 v140, v140, v84
    v_add_f32 v141, v141, v85
    v_add_f32 v142, v142, v86
    v_add_f32 v143, v143, v87
    v_cvt_pk_bf16_f32 v40, v140, v141
    v_cvt_pk_bf16_f32 v41, v142, v143
    v_cvt_pk_bf16_f32 v152, v92, v93
    v_lshlrev_b32 v92, 16, v152
    v_and_b32 v93, 0xffff0000, v152
    v_cvt_pk_bf16_f32 v152, v94, v95
    v_lshlrev_b32 v94, 16, v152
    v_and_b32 v95, 0xffff0000, v152
    v_add_f32 v92, v92, v29
    v_add_f32 v93, v93, v29
    v_add_f32 v94, v94, v29
    v_add_f32 v95, v95, v29
    v_cvt_pk_bf16_f32 v152, v92, v93
    v_lshlrev_b32 v92, 16, v152
    v_and_b32 v93, 0xffff0000, v152
    v_cvt_pk_bf16_f32 v152, v94, v95
    v_lshlrev_b32 v94, 16, v152
    v_and_b32 v95, 0xffff0000, v152
    v_lshlrev_b32 v140, 16, v126
    v_and_b32 v141, 0xffff0000, v126
    v_lshlrev_b32 v142, 16, v127
    v_and_b32 v143, 0xffff0000, v127
    v_add_f32 v140, v140, v92
    v_add_f32 v141, v141, v93
    v_add_f32 v142, v142, v94
    v_add_f32 v143, v143, v95
    v_cvt_pk_bf16_f32 v42, v140, v141
    v_cvt_pk_bf16_f32 v43, v142, v143
    v_cvt_pk_bf16_f32 v152, v100, v101
    v_lshlrev_b32 v100, 16, v152
    v_and_b32 v101, 0xffff0000, v152
    v_cvt_pk_bf16_f32 v152, v102, v103
    v_lshlrev_b32 v102, 16, v152
    v_and_b32 v103, 0xffff0000, v152
    v_add_f32 v100, v100, v29
    v_add_f32 v101, v101, v29
    v_add_f32 v102, v102, v29
    v_add_f32 v103, v103, v29
    v_cvt_pk_bf16_f32 v152, v100, v101
    v_lshlrev_b32 v100, 16, v152
    v_and_b32 v101, 0xffff0000, v152
    v_cvt_pk_bf16_f32 v152, v102, v103
    v_lshlrev_b32 v102, 16, v152
    v_and_b32 v103, 0xffff0000, v152
    v_lshlrev_b32 v140, 16, v130
    v_and_b32 v141, 0xffff0000, v130
    v_lshlrev_b32 v142, 16, v131
    v_and_b32 v143, 0xffff0000, v131
    v_add_f32 v140, v140, v100
    v_add_f32 v141, v141, v101
    v_add_f32 v142, v142, v102
    v_add_f32 v143, v143, v103
    v_cvt_pk_bf16_f32 v44, v140, v141
    v_cvt_pk_bf16_f32 v45, v142, v143
    v_cvt_pk_bf16_f32 v152, v108, v109
    v_lshlrev_b32 v108, 16, v152
    v_and_b32 v109, 0xffff0000, v152
    v_cvt_pk_bf16_f32 v152, v110, v111
    v_lshlrev_b32 v110, 16, v152
    v_and_b32 v111, 0xffff0000, v152
    v_add_f32 v108, v108, v29
    v_add_f32 v109, v109, v29
    v_add_f32 v110, v110, v29
    v_add_f32 v111, v111, v29
    v_cvt_pk_bf16_f32 v152, v108, v109
    v_lshlrev_b32 v108, 16, v152
    v_and_b32 v109, 0xffff0000, v152
    v_cvt_pk_bf16_f32 v152, v110, v111
    v_lshlrev_b32 v110, 16, v152
    v_and_b32 v111, 0xffff0000, v152
    v_lshlrev_b32 v140, 16, v134
    v_and_b32 v141, 0xffff0000, v134
    v_lshlrev_b32 v142, 16, v135
    v_and_b32 v143, 0xffff0000, v135
    v_add_f32 v140, v140, v108
    v_add_f32 v141, v141, v109
    v_add_f32 v142, v142, v110
    v_add_f32 v143, v143, v111
    v_cvt_pk_bf16_f32 v46, v140, v141
    v_cvt_pk_bf16_f32 v47, v142, v143
    s_nop 1
    v_permlane32_swap_b32 v40, v44
    v_permlane32_swap_b32 v42, v46
    v_permlane32_swap_b32 v41, v45
    v_permlane32_swap_b32 v43, v47
    s_nop 1
    v_permlane16_swap_b32 v40, v42
    v_permlane16_swap_b32 v44, v46
    v_permlane16_swap_b32 v41, v43
    v_permlane16_swap_b32 v45, v47
    v_add_u32 v22, 32768, v18
    buffer_store_dwordx4 v[40:43], v22, s[28:31], 0 offen
    buffer_store_dwordx4 v[44:47], v22, s[28:31], 0 offen offset:16
    s_endpgm
g2_loader:
    s_mov_b32 s32, s44
    s_mov_b32 s33, s45
    s_mov_b32 s34, 4194304
    s_mov_b32 s35, 0x00020000
    s_add_u32 s52, s8, 12582912
    s_addc_u32 s53, s9, 0
    s_mov_b32 s54, 4194304
    s_mov_b32 s55, 0x00020000
    s_sub_u32 s16, s16, 4
    v_lshrrev_b32 v3, 3, v1
    v_bfe_u32 v4, v1, 4, 2
    v_and_b32 v5, 7, v1
    s_mul_i32 s17, s14, 917504
    s_lshl_b32 s18, s16, 12
    s_add_u32 s17, s17, s18
    v_lshl_add_u32 v12, v1, 4, s17
    v_lshlrev_b32 v6, 1, v4
    v_xor_b32 v6, v6, v5
    s_lshl_b32 s17, s16, 4
    v_add_u32 v8, s17, v3
    s_lshl_b32 s18, s15, 7
    v_add_u32 v9, 0, v8
    v_lshlrev_b32 v16, 12, v9
    v_lshl_add_u32 v16, v6, 4, v16
    v_add_u32 v16, s18, v16
    v_add_u32 v9, 8, v8
    v_lshlrev_b32 v17, 12, v9
    v_lshl_add_u32 v17, v6, 4, v17
    v_add_u32 v17, s18, v17
    v_subrev_u32 v17, 1024, v17
    s_lshl_b32 s37, s16, 12
    s_lshl_b32 s43, s16, 11
    s_add_u32 s43, s43, 0x4000
    s_mov_b32 s38, 0
    s_mov_b32 s39, 0
    s_mov_b32 s40, 0
    s_add_u32 m0, s40, s37
    s_nop 0
    buffer_load_dwordx4 v12, s[20:23], s38 offen offset:0 lds
    buffer_load_dwordx4 v12, s[20:23], s38 offen offset:1024 lds
    buffer_load_dwordx4 v12, s[20:23], s38 offen offset:2048 lds
    buffer_load_dwordx4 v12, s[20:23], s38 offen offset:3072 lds
    s_add_u32 m0, s40, s43
    s_nop 0
    buffer_load_dwordx4 v16, s[24:27], s39 offen offset:0 lds
    buffer_load_dwordx4 v17, s[24:27], s39 offen offset:1024 lds
    s_add_u32 s38, s38, 0x4000
    s_add_u32 s39, s39, 262144
    s_add_u32 s40, s40, 24576
    s_cmp_eq_u32 s40, 122880
    s_cselect_b32 s40, 0, s40
    v_and_b32 v20, 15, v1
    s_lshl_b32 s17, s15, 6
    s_lshl_b32 s18, s16, 4
    s_add_u32 s17, s17, s18
    s_lshl_b32 s18, s14, 8
    s_add_u32 m0, s37, 122880
    v_add_u32 v21, 0, v4
    v_xor_b32 v22, v21, v20
    v_add_u32 v21, s17, v21
    v_lshlrev_b32 v21, 11, v21
    v_lshl_add_u32 v21, v22, 4, v21
    v_add_u32 v21, s18, v21
    buffer_load_dwordx4 v21, s[32:35], 0 offen offset:0 lds
    v_add_u32 v21, 4, v4
    v_xor_b32 v22, v21, v20
    v_add_u32 v21, s17, v21
    v_lshlrev_b32 v21, 11, v21
    v_lshl_add_u32 v21, v22, 4, v21
    v_add_u32 v21, s18, v21
    v_subrev_u32 v21, 1024, v21
    buffer_load_dwordx4 v21, s[32:35], 0 offen offset:1024 lds
    v_add_u32 v21, 8, v4
    v_xor_b32 v22, v21, v20
    v_add_u32 v21, s17, v21
    v_lshlrev_b32 v21, 11, v21
    v_lshl_add_u32 v21, v22, 4, v21
    v_add_u32 v21, s18, v21
    v_subrev_u32 v21, 2048, v21
    buffer_load_dwordx4 v21, s[32:35], 0 offen offset:2048 lds
    v_add_u32 v21, 12, v4
    v_xor_b32 v22, v21, v20
    v_add_u32 v21, s17, v21
    v_lshlrev_b32 v21, 11, v21
    v_lshl_add_u32 v21, v22, 4, v21
    v_add_u32 v21, s18, v21
    v_subrev_u32 v21, 3072, v21
    buffer_load_dwordx4 v21, s[32:35], 0 offen offset:3072 lds
    s_lshl_b32 s17, s14, 7
    s_lshl_b32 s18, s16, 5
    s_add_u32 s17, s17, s18
    s_lshl_b32 s18, s15, 7
    s_add_u32 m0, s37, 139264
    v_add_u32 v21, 0, v3
    v_add_u32 v21, s17, v21
    v_lshlrev_b32 v21, 12, v21
    v_lshl_add_u32 v21, v6, 4, v21
    v_add_u32 v21, s18, v21
    buffer_load_dwordx4 v21, s[52:55], 0 offen offset:0 lds
    v_add_u32 v21, 8, v3
    v_add_u32 v21, s17, v21
    v_lshlrev_b32 v21, 12, v21
    v_lshl_add_u32 v21, v6, 4, v21
    v_add_u32 v21, s18, v21
    v_subrev_u32 v21, 1024, v21
    buffer_load_dwordx4 v21, s[52:55], 0 offen offset:1024 lds
    v_add_u32 v21, 16, v3
    v_add_u32 v21, s17, v21
    v_lshlrev_b32 v21, 12, v21
    v_lshl_add_u32 v21, v6, 4, v21
    v_add_u32 v21, s18, v21
    v_subrev_u32 v21, 2048, v21
    buffer_load_dwordx4 v21, s[52:55], 0 offen offset:2048 lds
    v_add_u32 v21, 24, v3
    v_add_u32 v21, s17, v21
    v_lshlrev_b32 v21, 12, v21
    v_lshl_add_u32 v21, v6, 4, v21
    v_add_u32 v21, s18, v21
    v_subrev_u32 v21, 3072, v21
    buffer_load_dwordx4 v21, s[52:55], 0 offen offset:3072 lds
    s_add_u32 m0, s40, s37
    s_nop 0
    buffer_load_dwordx4 v12, s[20:23], s38 offen offset:0 lds
    buffer_load_dwordx4 v12, s[20:23], s38 offen offset:1024 lds
    buffer_load_dwordx4 v12, s[20:23], s38 offen offset:2048 lds
    buffer_load_dwordx4 v12, s[20:23], s38 offen offset:3072 lds
    s_add_u32 m0, s40, s43
    s_nop 0
    buffer_load_dwordx4 v16, s[24:27], s39 offen offset:0 lds
    buffer_load_dwordx4 v17, s[24:27], s39 offen offset:1024 lds
    s_add_u32 s38, s38, 0x4000
    s_add_u32 s39, s39, 262144
    s_add_u32 s40, s40, 24576
    s_cmp_eq_u32 s40, 122880
    s_cselect_b32 s40, 0, s40
    s_add_u32 m0, s40, s37
    s_nop 0
    buffer_load_dwordx4 v12, s[20:23], s38 offen offset:0 lds
    buffer_load_dwordx4 v12, s[20:23], s38 offen offset:1024 lds
    buffer_load_dwordx4 v12, s[20:23], s38 offen offset:2048 lds
    buffer_load_dwordx4 v12, s[20:23], s38 offen offset:3072 lds
    s_add_u32 m0, s40, s43
    s_nop 0
    buffer_load_dwordx4 v16, s[24:27], s39 offen offset:0 lds
    buffer_load_dwordx4 v17, s[24:27], s39 offen offset:1024 lds
    s_add_u32 s38, s38, 0x4000
    s_add_u32 s39, s39, 262144
    s_add_u32 s40, s40, 24576
    s_cmp_eq_u32 s40, 122880
    s_cselect_b32 s40, 0, s40
    s_add_u32 m0, s40, s37
    s_nop 0
    buffer_load_dwordx4 v12, s[20:23], s38 offen offset:0 lds
    buffer_load_dwordx4 v12, s[20:23], s38 offen offset:1024 lds
    buffer_load_dwordx4 v12, s[20:23], s38 offen offset:2048 lds
    buffer_load_dwordx4 v12, s[20:23], s38 offen offset:3072 lds
    s_add_u32 m0, s40, s43
    s_nop 0
    buffer_load_dwordx4 v16, s[24:27], s39 offen offset:0 lds
    buffer_load_dwordx4 v17, s[24:27], s39 offen offset:1024 lds
    s_add_u32 s38, s38, 0x4000
    s_add_u32 s39, s39, 262144
    s_add_u32 s40, s40, 24576
    s_cmp_eq_u32 s40, 122880
    s_cselect_b32 s40, 0, s40
    s_add_u32 m0, s40, s37
    s_nop 0
    buffer_load_dwordx4 v12, s[20:23], s38 offen offset:0 lds
    buffer_load_dwordx4 v12, s[20:23], s38 offen offset:1024 lds
    buffer_load_dwordx4 v12, s[20:23], s38 offen offset:2048 lds
    buffer_load_dwordx4 v12, s[20:23], s38 offen offset:3072 lds
    s_add_u32 m0, s40, s43
    s_nop 0
    buffer_load_dwordx4 v16, s[24:27], s39 offen offset:0 lds
    buffer_load_dwordx4 v17, s[24:27], s39 offen offset:1024 lds
    s_add_u32 s38, s38, 0x4000
    s_add_u32 s39, s39, 262144
    s_add_u32 s40, s40, 24576
    s_cmp_eq_u32 s40, 122880
    s_cselect_b32 s40, 0, s40
    s_waitcnt vmcnt(32)
    s_barrier
    s_mov_b32 s42, 0
g2_lloop:
    s_waitcnt vmcnt(18)
    s_barrier
    s_add_u32 m0, s40, s37
    s_nop 0
    buffer_load_dwordx4 v12, s[20:23], s38 offen offset:0 lds
    buffer_load_dwordx4 v12, s[20:23], s38 offen offset:1024 lds
    buffer_load_dwordx4 v12, s[20:23], s38 offen offset:2048 lds
    buffer_load_dwordx4 v12, s[20:23], s38 offen offset:3072 lds
    s_add_u32 m0, s40, s43
    s_nop 0
    buffer_load_dwordx4 v16, s[24:27], s39 offen offset:0 lds
    buffer_load_dwordx4 v17, s[24:27], s39 offen offset:1024 lds
    s_add_u32 s38, s38, 0x4000
    s_add_u32 s39, s39, 262144
    s_add_u32 s40, s40, 24576
    s_cmp_eq_u32 s40, 122880
    s_cselect_b32 s40, 0, s40
    s_add_u32 s42, s42, 1
    s_cmp_lt_u32 s42, 51
    s_cbranch_scc1 g2_lloop
    s_waitcnt vmcnt(18)
    s_barrier
    s_waitcnt vmcnt(12)
    s_barrier
    s_waitcnt vmcnt(6)
    s_barrier
    s_waitcnt vmcnt(0)
    s_barrier
    s_barrier
    s_endpgm
g2_done:
    s_endpgm
.section .rodata,"a"
.p2align 6
.amdhsa_kernel prep_kernel
  .amdhsa_next_free_vgpr 120
  .amdhsa_next_free_sgpr 48
  .amdhsa_accum_offset 120
  .amdhsa_group_segment_fixed_size 0
  .amdhsa_kernarg_size 112
  .amdhsa_user_sgpr_count 2
  .amdhsa_user_sgpr_kernarg_segment_ptr 1
  .amdhsa_system_sgpr_workgroup_id_x 1
.end_amdhsa_kernel
.p2align 6
.amdhsa_kernel gemm1_kernel
  .amdhsa_next_free_vgpr 160
  .amdhsa_next_free_sgpr 96
  .amdhsa_accum_offset 160
  .amdhsa_group_segment_fixed_size 0
  .amdhsa_kernarg_size 112
  .amdhsa_user_sgpr_count 2
  .amdhsa_user_sgpr_kernarg_segment_ptr 1
  .amdhsa_system_sgpr_workgroup_id_x 1
.end_amdhsa_kernel
.p2align 6
.amdhsa_kernel gemm2_kernel
  .amdhsa_next_free_vgpr 160
  .amdhsa_next_free_sgpr 90
  .amdhsa_accum_offset 160
  .amdhsa_group_segment_fixed_size 0
  .amdhsa_kernarg_size 112
  .amdhsa_user_sgpr_count 2
  .amdhsa_user_sgpr_kernarg_segment_ptr 1
  .amdhsa_system_sgpr_workgroup_id_x 1
.end_amdhsa_kernel
```
